```python
import torch

def _softmax(x, axis=-1):
    return torch.softmax(x, dim=axis)
def _gelu(x):
    return torch.nn.functional.gelu(x, approximate="tanh")
def _silu(x):
    return torch.nn.functional.silu(x)
def _sigmoid(x):
    return torch.sigmoid(x)
def _layernorm(x, axis=-1, eps=1e-5):
    m = x.mean(dim=axis, keepdim=True)
    v = x.var(dim=axis, keepdim=True, unbiased=False)
    return (x - m) / torch.sqrt(v + eps)
def _scatter_add(tgt, idx, src, axis=0):
    return tgt.clone().index_add_(axis, idx, src)
def _segment_sum(src, seg, n):
    out = torch.zeros((n,) + src.shape[1:], dtype=src.dtype)
    return out.index_add_(0, seg, src)
def _pad(x, pw):
    flat = tuple(v for pair in reversed(pw) for v in pair)
    return torch.nn.functional.pad(x, flat)

kernel_name = 'interleave_layers__sliding_block_cached__mixer_token_mlp__decode'

def setup_inputs():

    _w = (lambda a: (lambda t: t.to(torch.bfloat16) if t.is_floating_point() else t)(torch.as_tensor(a)))
    def _A_setup():
        B, Sq, D = 1, 1, 512
        Hq, Hkv, Sk, Dh = 32, 8, 65536, 128
        assert Hq % Hkv == 0, (Hq, Hkv)
        return {
            "x": _w((lambda *s: torch.randn(*s, dtype=torch.bfloat16) * 0.05)(B, Sq, D)),
            "k_cache": _w((lambda *s: torch.randn(*s, dtype=torch.bfloat16) * 0.8)(B, Hkv, Sk, Dh)),
            "v_cache": _w((lambda *s: torch.randn(*s, dtype=torch.bfloat16) * 1.6)(B, Hkv, Sk, Dh)),
            "wq": _w((lambda *s: torch.randn(*s, dtype=torch.bfloat16) * 0.8)(D, Hq * Dh) * (D ** -0.5)),
            "wo": _w((lambda *s: torch.randn(*s, dtype=torch.bfloat16) * 1.6)(Hq * Dh, D) * ((Hq * Dh) ** -0.5)),
        }
    _A_in = _A_setup()

    def _B_setup():
        B, S, D, F = 1, 1, 512, 1792
        return {
            "x": _w((lambda *s: torch.randn(*s, dtype=torch.bfloat16) * 0.05)(B, S, D)),
            "w1": _w((lambda *s: torch.randn(*s, dtype=torch.bfloat16) * 0.8)(S, F) * (S ** -0.5)),
            "b1": _w((lambda *s: torch.randn(*s, dtype=torch.bfloat16) * 0.2)(F) * 0.02),
            "w2": _w((lambda *s: torch.randn(*s, dtype=torch.bfloat16) * 0.2)(F, S) * (F ** -0.5)),
            "b2": _w((lambda *s: torch.randn(*s, dtype=torch.bfloat16) * 0.2)(S) * 0.02),
        }
    _B_in = _B_setup()

    return {
        "A_x": _A_in["x"],
        "A_k_cache": _A_in["k_cache"],
        "A_v_cache": _A_in["v_cache"],
        "A_wq": _A_in["wq"],
        "A_wo": _A_in["wo"],
        "B_x": _B_in["x"],
        "B_w1": _B_in["w1"],
        "B_b1": _B_in["b1"],
        "B_w2": _B_in["w2"],
        "B_b2": _B_in["b2"],
    }

def reference(A_x, A_k_cache, A_v_cache, A_wq, A_wo, B_x, B_w1, B_b1, B_w2, B_b2):
    def _A_ref(x, k_cache, v_cache, wq, wo):
        B, Sq, D = x.shape
        Hq, Dh = 32, 128
        Hkv, Sk = k_cache.shape[1], k_cache.shape[2]
        W = min(4096, max(256, Sk // 4))
        rep = Hq // Hkv
        q = (lambda x, *d: x.permute(*d))((x @ wq).reshape(B, Sq, Hq, Dh), 0, 2, 1, 3)
        k = (lambda x, n, axis: torch.repeat_interleave(x, n, dim=axis))(k_cache[:, :, Sk - W:, :], rep, axis=1)
        v = (lambda x, n, axis: torch.repeat_interleave(x, n, dim=axis))(v_cache[:, :, Sk - W:, :], rep, axis=1)
        scores = torch.einsum("bhqd,bhkd->bhqk", q, k) * (Dh ** -0.5)
        p = _softmax(scores, axis=-1)
        o = torch.einsum("bhqk,bhkd->bhqd", p, v)
        return (lambda x, *d: x.permute(*d))(o, 0, 2, 1, 3).reshape(B, Sq, Hq * Dh) @ wo

    def _B_ref(x, w1, b1, w2, b2):
        B, S, D = x.shape
        h = _layernorm(x, axis=-1)
        u = torch.einsum("bsd,sf->bdf", h, w1) + b1
        u = _gelu(u)
        y = torch.einsum("bdf,fs->bds", u, w2) + b2
        return (lambda x, *d: x.permute(*d))(y, 0, 2, 1)

    x = A_x
    x = x + _A_ref(_layernorm(x, axis=-1), A_k_cache, A_v_cache, A_wq, A_wo)
    x = x + _B_ref(_layernorm(x, axis=-1), B_w1, B_b1, B_w2, B_b2)
    x = x + _A_ref(_layernorm(x, axis=-1), A_k_cache, A_v_cache, A_wq, A_wo)
    x = x + _B_ref(_layernorm(x, axis=-1), B_w1, B_b1, B_w2, B_b2)
    return x
```

```asm
; @launch grid=(256,1,1) block=(320,1,1) lds=69632
.amdgcn_target "amdgcn-amd-amdhsa--gfx950"
.text
.globl interleave_layers__sliding_block_cached__mixer_token_mlp__decode_kernel
.p2align 8
.type interleave_layers__sliding_block_cached__mixer_token_mlp__decode_kernel,@function
interleave_layers__sliding_block_cached__mixer_token_mlp__decode_kernel:
    s_cmp_ge_u32 s2, 256
    s_cbranch_scc1 L_end
    s_load_dwordx16 s[4:19], s[0:1], 0
    s_load_dwordx8 s[20:27], s[0:1], 64
    s_load_dwordx2 s[28:29], s[0:1], 96
    s_and_b32 s30, s2, 7
    s_lshr_b32 s31, s2, 3
    s_lshl_b32 s33, s30, 5
    s_add_u32 s33, s33, s31
    v_and_b32 v1, 63, v0
    v_lshrrev_b32 v2, 6, v0
    s_nop 0
    v_readfirstlane_b32 s32, v2
    s_waitcnt lgkmcnt(0)
    s_load_dwordx2 s[66:67], s[28:29], 32768
    s_cmp_eq_u32 s32, 4
    s_cbranch_scc1 L_helper
    v_lshlrev_b32 v184, 4, v1
    s_lshr_b32 s42, s31, 3
    s_lshl_b32 s43, s42, 9
    v_lshlrev_b32 v12, 3, v1
    v_add_u32 v190, s43, v12
    v_and_b32 v13, 7, v1
    v_lshlrev_b32 v13, 2, v13
    s_lshl_b32 s43, s31, 5
    v_add_u32 v13, s43, v13
    s_barrier
    global_load_dword v8, v13, s[4:5]
    s_lshl_b32 s43, s30, 24
    s_add_u32 s43, s43, 15728640
    s_lshl_b32 s44, s31, 15
    s_add_u32 s43, s43, s44
    s_lshl_b32 s44, s32, 13
    s_add_u32 s43, s43, s44
    v_and_b32 v16, 15, v1
    v_lshlrev_b32 v16, 8, v16
    v_lshrrev_b32 v17, 4, v1
    v_lshlrev_b32 v17, 4, v17
    v_add3_u32 v16, v16, v17, s43
    v_add_u32 v17, 4096, v16
    global_load_dwordx4 v[64:67], v16, s[6:7] offset:0 nt
    global_load_dwordx4 v[68:71], v16, s[6:7] offset:64 nt
    global_load_dwordx4 v[72:75], v16, s[6:7] offset:128 nt
    global_load_dwordx4 v[76:79], v16, s[6:7] offset:192 nt
    global_load_dwordx4 v[80:83], v17, s[6:7] offset:0 nt
    global_load_dwordx4 v[84:87], v17, s[6:7] offset:64 nt
    global_load_dwordx4 v[88:91], v17, s[6:7] offset:128 nt
    global_load_dwordx4 v[92:95], v17, s[6:7] offset:192 nt
    v_add_u32 v18, s43, v184
    v_add_u32 v19, 4096, v18
    global_load_dwordx4 v[200:203], v18, s[8:9] offset:0 nt
    global_load_dwordx4 v[204:207], v18, s[8:9] offset:1024 nt
    global_load_dwordx4 v[208:211], v18, s[8:9] offset:2048 nt
    global_load_dwordx4 v[212:215], v18, s[8:9] offset:3072 nt
    global_load_dwordx4 v[216:219], v19, s[8:9] offset:0 nt
    global_load_dwordx4 v[220:223], v19, s[8:9] offset:1024 nt
    global_load_dwordx4 v[224:227], v19, s[8:9] offset:2048 nt
    global_load_dwordx4 v[228:231], v19, s[8:9] offset:3072 nt
    v_and_b32 v23, 4, v1
    v_cmp_ne_u32 s[76:77], 0, v23
    v_and_b32 v23, 8, v1
    v_cmp_ne_u32 s[78:79], 0, v23
    v_and_b32 v23, 16, v1
    v_cmp_ne_u32 s[80:81], 0, v23
    v_and_b32 v23, 32, v1
    v_cmp_ne_u32 s[82:83], 0, v23
    v_lshlrev_b32 v185, 3, v0
    s_mul_i32 s42, s31, 2176
    v_add_u32 v186, s42, v184
    v_and_b32 v23, 15, v1
    v_lshlrev_b32 v24, 6, v23
    v_lshrrev_b32 v25, 4, v1
    v_lshlrev_b32 v25, 4, v25
    v_add3_u32 v192, v24, v25, s42
    s_lshr_b32 s42, s31, 3
    s_lshl_b32 s42, s42, 8
    s_add_u32 s42, s42, 8192
    v_lshlrev_b32 v23, 3, v23
    v_add_u32 v187, s42, v23
    v_lshrrev_b32 v23, 3, v1
    v_lshlrev_b32 v24, 11, v23
    v_and_b32 v25, 7, v1
    v_lshlrev_b32 v26, 3, v25
    s_lshl_b32 s42, s31, 6
    s_add_u32 s42, s42, 0x140000
    v_add3_u32 v188, v24, v26, s42
    v_and_b32 v23, 3, v23
    v_lshlrev_b32 v23, 3, v23
    v_lshlrev_b32 v26, 6, v25
    s_lshl_b32 s42, s31, 9
    s_add_u32 s42, s42, 0x144000
    v_add_u32 v189, s42, v26
    v_lshrrev_b32 v23, 3, v0
    s_mov_b32 s42, 2176
    v_mul_lo_u32 v23, v23, s42
    v_and_b32 v24, 7, v0
    v_lshlrev_b32 v24, 3, v24
    s_lshl_b32 s42, s31, 6
    v_add3_u32 v191, v23, v24, s42
    s_add_u32 s40, s28, 196608
    s_addc_u32 s41, s29, 0
    s_mul_i32 s42, s30, 163840
    s_add_u32 s36, s40, s42
    s_addc_u32 s37, s41, 0
    s_waitcnt vmcnt(0)
    s_lshl_b32 s42, s32, 13
    v_add_u32 v40, s42, v184
    ds_write_b128 v40, v[200:203] offset:0
    ds_write_b128 v40, v[204:207] offset:1024
    ds_write_b128 v40, v[208:211] offset:2048
    ds_write_b128 v40, v[212:215] offset:3072
    ds_write_b128 v40, v[216:219] offset:4096
    ds_write_b128 v40, v[220:223] offset:5120
    ds_write_b128 v40, v[224:227] offset:6144
    ds_write_b128 v40, v[228:231] offset:7168
    v_lshrrev_b32 v41, 4, v1
    v_and_b32 v42, 15, v1
    v_lshrrev_b32 v43, 2, v42
    v_lshl_add_u32 v43, v41, 2, v43
    v_lshlrev_b32 v43, 8, v43
    v_and_b32 v42, 3, v42
    v_lshl_add_u32 v43, v42, 3, v43
    v_add_u32 v43, s42, v43
    s_waitcnt lgkmcnt(0)
    ds_read_b64_tr_b16 v[96:97], v43 offset:0
    ds_read_b64_tr_b16 v[98:99], v43 offset:4096
    ds_read_b64_tr_b16 v[100:101], v43 offset:32
    ds_read_b64_tr_b16 v[102:103], v43 offset:4128
    ds_read_b64_tr_b16 v[104:105], v43 offset:64
    ds_read_b64_tr_b16 v[106:107], v43 offset:4160
    ds_read_b64_tr_b16 v[108:109], v43 offset:96
    ds_read_b64_tr_b16 v[110:111], v43 offset:4192
    ds_read_b64_tr_b16 v[112:113], v43 offset:128
    ds_read_b64_tr_b16 v[114:115], v43 offset:4224
    ds_read_b64_tr_b16 v[116:117], v43 offset:160
    ds_read_b64_tr_b16 v[118:119], v43 offset:4256
    ds_read_b64_tr_b16 v[120:121], v43 offset:192
    ds_read_b64_tr_b16 v[122:123], v43 offset:4288
    ds_read_b64_tr_b16 v[124:125], v43 offset:224
    ds_read_b64_tr_b16 v[126:127], v43 offset:4320
    v_lshlrev_b32 v182, 16, v8
    v_and_b32 v183, 0xffff0000, v8
    s_waitcnt lgkmcnt(0)
    s_add_u32 s66, s66, 1
    s_addc_u32 s67, s67, 0
    s_lshl_b32 s43, s30, 19
    s_lshl_b32 s44, s31, 14
    s_add_u32 s43, s43, s44
    s_lshl_b32 s44, s32, 8
    s_add_u32 s43, s43, s44
    v_lshrrev_b32 v58, 4, v1
    v_lshlrev_b32 v58, 10, v58
    v_and_b32 v59, 15, v1
    v_lshlrev_b32 v59, 4, v59
    v_add3_u32 v58, v58, v59, s43
    global_load_dwordx4 v[232:235], v58, s[12:13] nt
    v_add_u32 v58, 4096, v58
    global_load_dwordx4 v[236:239], v58, s[12:13] nt
    v_add_u32 v58, 4096, v58
    global_load_dwordx4 v[240:243], v58, s[12:13] nt
    v_add_u32 v58, 4096, v58
    global_load_dwordx4 v[244:247], v58, s[12:13] nt
    v_lshlrev_b32 v59, 1, v0
    global_load_ushort v160, v59, s[16:17] offset:0
    global_load_ushort v167, v59, s[18:19] offset:0
    global_load_ushort v174, v59, s[20:21] offset:0
    global_load_ushort v161, v59, s[16:17] offset:512
    global_load_ushort v168, v59, s[18:19] offset:512
    global_load_ushort v175, v59, s[20:21] offset:512
    global_load_ushort v162, v59, s[16:17] offset:1024
    global_load_ushort v169, v59, s[18:19] offset:1024
    global_load_ushort v176, v59, s[20:21] offset:1024
    global_load_ushort v163, v59, s[16:17] offset:1536
    global_load_ushort v170, v59, s[18:19] offset:1536
    global_load_ushort v177, v59, s[20:21] offset:1536
    global_load_ushort v164, v59, s[16:17] offset:2048
    global_load_ushort v171, v59, s[18:19] offset:2048
    global_load_ushort v178, v59, s[20:21] offset:2048
    global_load_ushort v165, v59, s[16:17] offset:2560
    global_load_ushort v172, v59, s[18:19] offset:2560
    global_load_ushort v179, v59, s[20:21] offset:2560
    global_load_ushort v166, v59, s[16:17] offset:3072
    global_load_ushort v173, v59, s[18:19] offset:3072
    global_load_ushort v180, v59, s[20:21] offset:3072
    v_mov_b32 v60, 0
    global_load_ushort v181, v60, s[22:23]
    s_barrier
    v_and_b32 v40, 3, v1
    v_mul_u32_u24 v40, 272, v40
    v_lshrrev_b32 v41, 4, v1
    v_lshl_add_u32 v40, v41, 4, v40
    ds_read_b128 v[2:5], v40 offset:32768
    ds_read_b128 v[6:9], v40 offset:32832
    ds_read_b128 v[10:13], v40 offset:32896
    ds_read_b128 v[14:17], v40 offset:32960
    s_mov_b32 s52, 0x3db504f3
    s_mov_b32 s53, 0x3fb8aa3b
    s_waitcnt lgkmcnt(0)
    s_nop 0
    v_mfma_f32_16x16x32_bf16 v[24:27], v[64:67], v[2:5], 0
    v_mfma_f32_16x16x32_bf16 v[28:31], v[80:83], v[2:5], 0
    v_mfma_f32_16x16x32_bf16 v[24:27], v[68:71], v[6:9], v[24:27]
    v_mfma_f32_16x16x32_bf16 v[28:31], v[84:87], v[6:9], v[28:31]
    v_mfma_f32_16x16x32_bf16 v[24:27], v[72:75], v[10:13], v[24:27]
    v_mfma_f32_16x16x32_bf16 v[28:31], v[88:91], v[10:13], v[28:31]
    v_mfma_f32_16x16x32_bf16 v[24:27], v[76:79], v[14:17], v[24:27]
    v_mfma_f32_16x16x32_bf16 v[28:31], v[92:95], v[14:17], v[28:31]
    v_and_b32 v40, 3, v1
    v_mul_u32_u24 v42, 576, v40
    v_lshl_add_u32 v42, v41, 4, v42
    v_bfe_u32 v40, v1, 2, 2
    v_lshl_add_u32 v42, v40, 7, v42
    s_mul_i32 s42, s32, 2304
    v_add_u32 v42, s42, v42
    s_lshl_b32 s42, s32, 3
    v_lshlrev_b32 v43, 5, v1
    v_add_u32 v43, s42, v43
    s_nop 2
    v_cvt_pk_bf16_f32 v44, v24, v25
    v_lshlrev_b32 v24, 16, v44
    v_and_b32 v25, 0xffff0000, v44
    v_mul_f32 v24, s52, v24
    v_mul_f32 v25, s52, v25
    v_cvt_pk_bf16_f32 v44, v24, v25
    v_lshlrev_b32 v24, 16, v44
    v_and_b32 v25, 0xffff0000, v44
    v_cvt_pk_bf16_f32 v44, v26, v27
    v_lshlrev_b32 v26, 16, v44
    v_and_b32 v27, 0xffff0000, v44
    v_mul_f32 v26, s52, v26
    v_mul_f32 v27, s52, v27
    v_cvt_pk_bf16_f32 v44, v26, v27
    v_lshlrev_b32 v26, 16, v44
    v_and_b32 v27, 0xffff0000, v44
    v_cvt_pk_bf16_f32 v44, v28, v29
    v_lshlrev_b32 v28, 16, v44
    v_and_b32 v29, 0xffff0000, v44
    v_mul_f32 v28, s52, v28
    v_mul_f32 v29, s52, v29
    v_cvt_pk_bf16_f32 v44, v28, v29
    v_lshlrev_b32 v28, 16, v44
    v_and_b32 v29, 0xffff0000, v44
    v_cvt_pk_bf16_f32 v44, v30, v31
    v_lshlrev_b32 v30, 16, v44
    v_and_b32 v31, 0xffff0000, v44
    v_mul_f32 v30, s52, v30
    v_mul_f32 v31, s52, v31
    v_cvt_pk_bf16_f32 v44, v30, v31
    v_lshlrev_b32 v30, 16, v44
    v_and_b32 v31, 0xffff0000, v44
    v_max3_f32 v34, v24, v25, v26
    v_max3_f32 v34, v34, v27, v28
    v_max3_f32 v34, v34, v29, v30
    v_max_f32 v34, v34, v31
    v_mov_b32 v44, v34
    s_nop 1
    v_permlane16_swap_b32 v44, v34
    s_nop 0
    v_max_f32 v34, v34, v44
    v_mov_b32 v44, v34
    s_nop 1
    v_permlane32_swap_b32 v44, v34
    s_nop 0
    v_max_f32 v34, v34, v44
    v_mul_f32 v45, s53, v34
    v_fma_f32 v24, v24, s53, -v45
    v_fma_f32 v25, v25, s53, -v45
    v_fma_f32 v26, v26, s53, -v45
    v_fma_f32 v27, v27, s53, -v45
    v_fma_f32 v28, v28, s53, -v45
    v_fma_f32 v29, v29, s53, -v45
    v_fma_f32 v30, v30, s53, -v45
    v_fma_f32 v31, v31, s53, -v45
    v_exp_f32 v24, v24
    v_exp_f32 v25, v25
    v_exp_f32 v26, v26
    v_exp_f32 v27, v27
    v_exp_f32 v28, v28
    v_exp_f32 v29, v29
    v_exp_f32 v30, v30
    v_exp_f32 v31, v31
    s_nop 0
    v_cvt_pk_bf16_f32 v36, v24, v25
    v_cvt_pk_bf16_f32 v37, v26, v27
    v_cvt_pk_bf16_f32 v38, v28, v29
    v_cvt_pk_bf16_f32 v39, v30, v31
    v_add_f32 v35, v24, v25
    v_add_f32 v35, v35, v26
    v_mfma_f32_16x16x32_bf16 v[200:203], v[96:99], v[36:39], 0
    v_mfma_f32_16x16x32_bf16 v[204:207], v[100:103], v[36:39], 0
    v_mfma_f32_16x16x32_bf16 v[208:211], v[104:107], v[36:39], 0
    v_mfma_f32_16x16x32_bf16 v[212:215], v[108:111], v[36:39], 0
    v_mfma_f32_16x16x32_bf16 v[216:219], v[112:115], v[36:39], 0
    v_mfma_f32_16x16x32_bf16 v[220:223], v[116:119], v[36:39], 0
    v_mfma_f32_16x16x32_bf16 v[224:227], v[120:123], v[36:39], 0
    v_mfma_f32_16x16x32_bf16 v[228:231], v[124:127], v[36:39], 0
    v_add_f32 v35, v35, v27
    v_add_f32 v35, v35, v28
    v_add_f32 v35, v35, v29
    v_add_f32 v35, v35, v30
    v_add_f32 v35, v35, v31
    v_mov_b32 v44, v35
    s_nop 1
    v_permlane16_swap_b32 v44, v35
    s_nop 0
    v_add_f32 v35, v35, v44
    v_mov_b32 v44, v35
    s_nop 1
    v_permlane32_swap_b32 v44, v35
    s_nop 0
    v_add_f32 v35, v35, v44
    s_nop 3
    v_cndmask_b32 v2, v200, v208, s[76:77]
    v_cndmask_b32 v10, v216, v224, s[76:77]
    v_cndmask_b32 v3, v201, v209, s[76:77]
    v_cndmask_b32 v11, v217, v225, s[76:77]
    v_cndmask_b32 v4, v202, v210, s[76:77]
    v_cndmask_b32 v12, v218, v226, s[76:77]
    v_cndmask_b32 v5, v203, v211, s[76:77]
    v_cndmask_b32 v13, v219, v227, s[76:77]
    v_cndmask_b32 v6, v204, v212, s[76:77]
    v_cndmask_b32 v14, v220, v228, s[76:77]
    v_cndmask_b32 v7, v205, v213, s[76:77]
    v_cndmask_b32 v15, v221, v229, s[76:77]
    v_cndmask_b32 v8, v206, v214, s[76:77]
    v_cndmask_b32 v16, v222, v230, s[76:77]
    v_cndmask_b32 v9, v207, v215, s[76:77]
    v_cndmask_b32 v17, v223, v231, s[76:77]
    v_cndmask_b32 v2, v2, v10, s[78:79]
    v_cndmask_b32 v3, v3, v11, s[78:79]
    v_cndmask_b32 v4, v4, v12, s[78:79]
    v_cndmask_b32 v5, v5, v13, s[78:79]
    v_cndmask_b32 v6, v6, v14, s[78:79]
    v_cndmask_b32 v7, v7, v15, s[78:79]
    v_cndmask_b32 v8, v8, v16, s[78:79]
    v_cndmask_b32 v9, v9, v17, s[78:79]
    ds_write_b128 v42, v[2:5] offset:0
    ds_write_b128 v42, v[6:9] offset:64
    v_cmp_gt_u32 vcc, 4, v1
    s_and_saveexec_b64 s[50:51], vcc
    ds_write_b64 v43, v[34:35] offset:10240
    s_mov_b64 exec, s[50:51]
    s_waitcnt lgkmcnt(0)
    s_barrier
    v_mov_b32 v58, 33888
    ds_read_b32 v58, v58
    s_mul_i32 s42, s32, 576
    v_lshlrev_b32 v57, 3, v1
    v_add_u32 v57, s42, v57
    ds_read_b64 v[2:3], v57 offset:0
    ds_read_b64 v[4:5], v57 offset:2304
    ds_read_b64 v[6:7], v57 offset:4608
    ds_read_b64 v[8:9], v57 offset:6912
    s_lshl_b32 s42, s32, 5
    v_mov_b32 v40, s42
    ds_read_b128 v[12:15], v40 offset:10240
    ds_read_b128 v[16:19], v40 offset:10256
    s_waitcnt lgkmcnt(0)
    v_readfirstlane_b32 s34, v58
    v_max3_f32 v20, v12, v14, v16
    v_max_f32 v20, v20, v18
    v_sub_f32 v12, v12, v20
    v_sub_f32 v14, v14, v20
    v_sub_f32 v16, v16, v20
    v_sub_f32 v18, v18, v20
    v_mul_f32 v12, s53, v12
    v_mul_f32 v14, s53, v14
    v_mul_f32 v16, s53, v16
    v_mul_f32 v18, s53, v18
    v_exp_f32 v12, v12
    v_exp_f32 v14, v14
    v_exp_f32 v16, v16
    v_exp_f32 v18, v18
    s_nop 0
    v_mul_f32 v21, v12, v13
    v_mul_f32 v2, v12, v2
    v_mul_f32 v3, v12, v3
    v_fmac_f32 v21, v14, v15
    v_fmac_f32 v2, v14, v4
    v_fmac_f32 v3, v14, v5
    v_fmac_f32 v21, v16, v17
    v_fmac_f32 v2, v16, v6
    v_fmac_f32 v3, v16, v7
    v_fmac_f32 v21, v18, v19
    v_fmac_f32 v2, v18, v8
    v_fmac_f32 v3, v18, v9
    s_lshl_b32 s42, s32, 8
    s_lshl_b32 s43, s31, 3
    s_add_u32 s42, s42, s43
    s_add_u32 s42, s42, 8192
    v_mov_b32 v41, s42
    v_add_u32 v40, 13312, v191
    s_cmp_eq_u32 s34, 0
    s_cbranch_scc0 sl_1
    global_store_dwordx2 v40, v[2:3], s[36:37]
    s_branch sld_2
sl_1:
    global_store_dwordx2 v40, v[2:3], s[36:37] sc1
sld_2:
    v_cmp_eq_u32 vcc, 0, v1
    s_and_saveexec_b64 s[50:51], vcc
    s_cmp_eq_u32 s34, 0
    s_cbranch_scc0 sl_3
    global_store_dwordx2 v41, v[20:21], s[36:37]
    s_branch sld_4
sl_3:
    global_store_dwordx2 v41, v[20:21], s[36:37] sc1
sld_4:
    s_mov_b64 exec, s[50:51]
    v_add_u32 v40, 13312, v192
    s_mov_b32 s35, 0x8000
poll_5:
    global_load_dwordx4 v[2:5], v40, s[36:37] sc1
    global_load_dwordx4 v[6:9], v40, s[36:37] offset:1024 sc1
    global_load_dwordx2 v[10:11], v187, s[36:37] sc1
    global_load_dwordx2 v[12:13], v187, s[36:37] offset:128 sc1
pollc_7:
    s_waitcnt vmcnt(0)
    v_max3_u32 v41, v2, v3, v4
    v_max3_u32 v41, v41, v5, v6
    v_max3_u32 v41, v41, v7, v8
    v_max3_u32 v41, v41, v9, v10
    v_max3_u32 v41, v41, v11, v12
    v_max_u32 v41, v41, v13
    v_cmp_eq_u32 vcc, -1, v41
    s_cbranch_vccz polld_6
    s_sub_u32 s35, s35, 1
    s_cbranch_scc0 poll_5
polld_6:
    s_lshl_b32 s42, s32, 12
    v_add_u32 v46, s42, v184
    ds_write_b128 v46, v[232:235] offset:53248
    ds_write_b128 v46, v[236:239] offset:54272
    ds_write_b128 v46, v[240:243] offset:55296
    ds_write_b128 v46, v[244:247] offset:56320
    v_lshrrev_b32 v47, 4, v1
    v_and_b32 v48, 15, v1
    v_lshrrev_b32 v49, 2, v48
    v_lshl_add_u32 v47, v47, 2, v49
    v_lshlrev_b32 v47, 8, v47
    v_and_b32 v48, 3, v48
    v_lshl_add_u32 v47, v48, 3, v47
    v_add_u32 v47, s42, v47
    v_max_f32 v14, v10, v12
    s_nop 1
    v_max_f32_dpp v14, v14, v14 quad_perm:[1,0,3,2] row_mask:0xf bank_mask:0xf
    s_nop 1
    v_max_f32_dpp v14, v14, v14 quad_perm:[2,3,0,1] row_mask:0xf bank_mask:0xf
    s_nop 1
    v_max_f32_dpp v14, v14, v14 row_ror:4 row_mask:0xf bank_mask:0xf
    s_nop 1
    v_max_f32_dpp v14, v14, v14 row_ror:8 row_mask:0xf bank_mask:0xf
    s_waitcnt lgkmcnt(0)
    ds_read_b64_tr_b16 v[144:145], v47 offset:53248
    ds_read_b64_tr_b16 v[146:147], v47 offset:53280
    ds_read_b64_tr_b16 v[148:149], v47 offset:53312
    ds_read_b64_tr_b16 v[150:151], v47 offset:53344
    ds_read_b64_tr_b16 v[152:153], v47 offset:53376
    ds_read_b64_tr_b16 v[154:155], v47 offset:53408
    ds_read_b64_tr_b16 v[156:157], v47 offset:53440
    ds_read_b64_tr_b16 v[158:159], v47 offset:53472
    v_sub_f32 v10, v10, v14
    v_sub_f32 v12, v12, v14
    v_mul_f32 v10, s53, v10
    v_mul_f32 v12, s53, v12
    v_exp_f32 v10, v10
    v_exp_f32 v12, v12
    s_nop 0
    v_mul_f32 v15, v10, v11
    v_fmac_f32 v15, v12, v13
    v_mul_f32 v2, v10, v2
    v_fmac_f32 v2, v12, v6
    v_mul_f32 v3, v10, v3
    v_fmac_f32 v3, v12, v7
    v_mul_f32 v4, v10, v4
    v_fmac_f32 v4, v12, v8
    v_mul_f32 v5, v10, v5
    v_fmac_f32 v5, v12, v9
    v_add_f32_dpp v15, v15, v15 quad_perm:[1,0,3,2] row_mask:0xf bank_mask:0xf
    v_add_f32_dpp v2, v2, v2 quad_perm:[1,0,3,2] row_mask:0xf bank_mask:0xf
    v_add_f32_dpp v3, v3, v3 quad_perm:[1,0,3,2] row_mask:0xf bank_mask:0xf
    v_add_f32_dpp v4, v4, v4 quad_perm:[1,0,3,2] row_mask:0xf bank_mask:0xf
    v_add_f32_dpp v5, v5, v5 quad_perm:[1,0,3,2] row_mask:0xf bank_mask:0xf
    v_add_f32_dpp v15, v15, v15 quad_perm:[2,3,0,1] row_mask:0xf bank_mask:0xf
    v_add_f32_dpp v2, v2, v2 quad_perm:[2,3,0,1] row_mask:0xf bank_mask:0xf
    v_add_f32_dpp v3, v3, v3 quad_perm:[2,3,0,1] row_mask:0xf bank_mask:0xf
    v_add_f32_dpp v4, v4, v4 quad_perm:[2,3,0,1] row_mask:0xf bank_mask:0xf
    v_add_f32_dpp v5, v5, v5 quad_perm:[2,3,0,1] row_mask:0xf bank_mask:0xf
    v_add_f32_dpp v15, v15, v15 row_ror:4 row_mask:0xf bank_mask:0xf
    v_add_f32_dpp v2, v2, v2 row_ror:4 row_mask:0xf bank_mask:0xf
    v_add_f32_dpp v3, v3, v3 row_ror:4 row_mask:0xf bank_mask:0xf
    v_add_f32_dpp v4, v4, v4 row_ror:4 row_mask:0xf bank_mask:0xf
    v_add_f32_dpp v5, v5, v5 row_ror:4 row_mask:0xf bank_mask:0xf
    v_add_f32_dpp v15, v15, v15 row_ror:8 row_mask:0xf bank_mask:0xf
    v_add_f32_dpp v2, v2, v2 row_ror:8 row_mask:0xf bank_mask:0xf
    v_add_f32_dpp v3, v3, v3 row_ror:8 row_mask:0xf bank_mask:0xf
    v_add_f32_dpp v4, v4, v4 row_ror:8 row_mask:0xf bank_mask:0xf
    v_add_f32_dpp v5, v5, v5 row_ror:8 row_mask:0xf bank_mask:0xf
    v_rcp_f32 v15, v15
    s_nop 0
    v_mul_f32 v2, v2, v15
    v_mul_f32 v3, v3, v15
    v_mul_f32 v4, v4, v15
    v_mul_f32 v5, v5, v15
    v_cvt_pk_bf16_f32 v16, v2, v3
    v_cvt_pk_bf16_f32 v17, v4, v5
    s_mul_i32 s42, s32, 17408
    s_lshl_b32 s43, s31, 6
    s_add_u32 s42, s42, s43
    s_add_u32 s42, s42, 82944
    v_and_b32 v50, 15, v1
    v_lshlrev_b32 v50, 2, v50
    v_lshrrev_b32 v51, 4, v1
    v_mul_u32_u24 v51, 4352, v51
    v_add3_u32 v50, v50, v51, s42
    s_waitcnt lgkmcnt(0)
    v_mfma_f32_16x16x16_bf16 v[200:203], v[16:17], v[144:145], 0
    v_mfma_f32_16x16x16_bf16 v[204:207], v[16:17], v[146:147], 0
    v_mfma_f32_16x16x16_bf16 v[208:211], v[16:17], v[148:149], 0
    v_mfma_f32_16x16x16_bf16 v[212:215], v[16:17], v[150:151], 0
    v_mfma_f32_16x16x16_bf16 v[216:219], v[16:17], v[152:153], 0
    v_mfma_f32_16x16x16_bf16 v[220:223], v[16:17], v[154:155], 0
    v_mfma_f32_16x16x16_bf16 v[224:227], v[16:17], v[156:157], 0
    v_mfma_f32_16x16x16_bf16 v[228:231], v[16:17], v[158:159], 0
    s_nop 7
    v_cndmask_b32 v2, v200, v208, s[80:81]
    v_cndmask_b32 v4, v216, v224, s[80:81]
    v_cndmask_b32 v3, v204, v212, s[80:81]
    v_cndmask_b32 v5, v220, v228, s[80:81]
    v_cndmask_b32 v2, v2, v4, s[82:83]
    v_cndmask_b32 v3, v3, v5, s[82:83]
    s_cmp_eq_u32 s34, 0
    s_cbranch_scc0 sl_8
    global_store_dword v50, v2, s[36:37]
    global_store_dword v50, v3, s[36:37] offset:2176
    s_branch sld_9
sl_8:
    global_store_dword v50, v2, s[36:37] sc1
    global_store_dword v50, v3, s[36:37] offset:2176 sc1
sld_9:
    s_cmp_eq_u32 s32, 0
    s_cbranch_scc0 w0_10
    v_add_u32 v40, 82944, v186
    s_mov_b32 s35, 0x8000
poll_11:
    global_load_dwordx4 v[2:5], v40, s[36:37] sc1
    global_load_dwordx4 v[6:9], v40, s[36:37] offset:1024 sc1
pollc_13:
    s_waitcnt vmcnt(0)
    v_max3_u32 v41, v2, v3, v4
    v_max3_u32 v41, v41, v5, v6
    v_max3_u32 v41, v41, v7, v8
    v_max_u32 v41, v41, v9
    v_cmp_eq_u32 vcc, -1, v41
    s_cbranch_vccz polld_12
    s_sub_u32 s35, s35, 1
    s_cbranch_scc0 poll_11
polld_12:
    v_add_f32 v2, v2, v6
    v_add_f32 v3, v3, v7
    v_add_f32 v4, v4, v8
    v_add_f32 v5, v5, v9
    v_add_f32_dpp v2, v2, v2 row_ror:4 row_mask:0xf bank_mask:0xf
    v_add_f32_dpp v3, v3, v3 row_ror:4 row_mask:0xf bank_mask:0xf
    v_add_f32_dpp v4, v4, v4 row_ror:4 row_mask:0xf bank_mask:0xf
    v_add_f32_dpp v5, v5, v5 row_ror:4 row_mask:0xf bank_mask:0xf
    v_add_f32_dpp v2, v2, v2 row_ror:8 row_mask:0xf bank_mask:0xf
    v_add_f32_dpp v3, v3, v3 row_ror:8 row_mask:0xf bank_mask:0xf
    v_add_f32_dpp v4, v4, v4 row_ror:8 row_mask:0xf bank_mask:0xf
    v_add_f32_dpp v5, v5, v5 row_ror:8 row_mask:0xf bank_mask:0xf
    v_mov_b32 v40, v2
    v_mov_b32 v41, v3
    v_mov_b32 v42, v4
    v_mov_b32 v43, v5
    s_nop 0
    v_permlane16_swap_b32 v40, v2
    v_permlane16_swap_b32 v41, v3
    v_permlane16_swap_b32 v42, v4
    v_permlane16_swap_b32 v43, v5
    s_nop 0
    v_add_f32 v2, v2, v40
    v_add_f32 v3, v3, v41
    v_add_f32 v4, v4, v42
    v_add_f32 v5, v5, v43
    v_mov_b32 v40, v2
    v_mov_b32 v41, v3
    v_mov_b32 v42, v4
    v_mov_b32 v43, v5
    s_nop 0
    v_permlane32_swap_b32 v40, v2
    v_permlane32_swap_b32 v41, v3
    v_permlane32_swap_b32 v42, v4
    v_permlane32_swap_b32 v43, v5
    s_nop 0
    v_add_f32 v2, v2, v40
    v_add_f32 v3, v3, v41
    v_add_f32 v4, v4, v42
    v_add_f32 v5, v5, v43
    s_lshl_b32 s42, s30, 11
    s_lshl_b32 s43, s31, 6
    s_add_u32 s42, s42, s43
    s_add_u32 s42, s42, 0x140000
    v_add_u32 v40, s42, v184
    v_cmp_gt_u32 vcc, 4, v1
    s_and_saveexec_b64 s[50:51], vcc
    global_store_dwordx4 v40, v[2:5], s[40:41] sc1
    s_mov_b64 exec, s[50:51]
    v_and_b32 v24, 7, v1
    v_lshlrev_b32 v24, 2, v24
    s_mov_b32 s35, 0x8000
poll_14:
    global_load_dwordx2 v[2:3], v188, s[40:41] sc1
    global_load_dword v25, v24, s[26:27] offset:192 sc1
pollc_16:
    s_waitcnt vmcnt(0)
    v_max_u32 v40, v2, v3
    v_cmp_eq_u32 vcc, -1, v40
    v_cmp_eq_u32 s[64:65], 0, v25
    s_or_b64 vcc, vcc, s[64:65]
    s_cbranch_vccz polld_15
    s_sub_u32 s35, s35, 1
    s_cbranch_scc0 poll_14
polld_15:
    s_nop 0
    v_add_f32_dpp v2, v2, v2 row_ror:8 row_mask:0xf bank_mask:0xf
    v_add_f32_dpp v3, v3, v3 row_ror:8 row_mask:0xf bank_mask:0xf
    v_mov_b32 v40, v2
    v_mov_b32 v41, v3
    s_nop 0
    v_permlane16_swap_b32 v40, v2
    v_permlane16_swap_b32 v41, v3
    s_nop 0
    v_add_f32 v2, v2, v40
    v_add_f32 v3, v3, v41
    v_mov_b32 v40, v2
    v_mov_b32 v41, v3
    s_nop 0
    v_permlane32_swap_b32 v40, v2
    v_permlane32_swap_b32 v41, v3
    s_nop 0
    v_add_f32 v2, v2, v40
    v_add_f32 v3, v3, v41
    v_cvt_pk_bf16_f32 v40, v2, v3
    v_lshlrev_b32 v2, 16, v40
    v_and_b32 v3, 0xffff0000, v40
    v_add_f32 v182, v182, v2
    v_add_f32 v183, v183, v3
    v_cvt_pk_bf16_f32 v40, v182, v183
    v_lshlrev_b32 v182, 16, v40
    v_and_b32 v183, 0xffff0000, v40
    s_lshl_b32 s42, s31, 6
    s_add_u32 s42, s42, 9216
    v_lshlrev_b32 v40, 3, v1
    v_add_u32 v40, s42, v40
    v_cmp_gt_u32 vcc, 8, v1
    s_and_saveexec_b64 s[50:51], vcc
    s_cmp_eq_u32 s34, 0
    s_cbranch_scc0 sl_17
    global_store_dwordx2 v40, v[182:183], s[36:37]
    s_branch sld_18
sl_17:
    global_store_dwordx2 v40, v[182:183], s[36:37] sc1
sld_18:
    s_mov_b64 exec, s[50:51]
    v_lshlrev_b32 v41, 5, v1
    v_add_u32 v40, 9216, v41
    s_mov_b32 s35, 0x8000
poll_19:
    global_load_dwordx4 v[2:5], v40, s[36:37] sc1
    global_load_dwordx4 v[6:9], v40, s[36:37] offset:16 sc1
pollc_21:
    s_waitcnt vmcnt(0)
    v_max3_u32 v42, v2, v3, v4
    v_max3_u32 v42, v42, v5, v6
    v_max3_u32 v42, v42, v7, v8
    v_max_u32 v42, v42, v9
    v_cmp_eq_u32 vcc, -1, v42
    s_cbranch_vccz polld_20
    s_sub_u32 s35, s35, 1
    s_cbranch_scc0 poll_19
polld_20:
    ds_write_b128 v41, v[2:5] offset:16384
    ds_write_b128 v41, v[6:9] offset:16400
    s_waitcnt lgkmcnt(0)
w0_10:
    s_barrier
    v_lshlrev_b32 v40, 5, v1
    s_lshl_b32 s42, s2, 3
    v_mov_b32 v41, s42
    ds_read_b128 v[2:5], v40 offset:16384
    ds_read_b128 v[6:9], v40 offset:16400
    ds_read_b64 v[10:11], v41 offset:16384
    s_waitcnt lgkmcnt(0)
    v_lshlrev_b32 v160, 16, v160
    v_lshlrev_b32 v167, 16, v167
    v_lshlrev_b32 v174, 16, v174
    v_lshlrev_b32 v161, 16, v161
    v_lshlrev_b32 v168, 16, v168
    v_lshlrev_b32 v175, 16, v175
    v_lshlrev_b32 v162, 16, v162
    v_lshlrev_b32 v169, 16, v169
    v_lshlrev_b32 v176, 16, v176
    v_lshlrev_b32 v163, 16, v163
    v_lshlrev_b32 v170, 16, v170
    v_lshlrev_b32 v177, 16, v177
    v_lshlrev_b32 v164, 16, v164
    v_lshlrev_b32 v171, 16, v171
    v_lshlrev_b32 v178, 16, v178
    v_lshlrev_b32 v165, 16, v165
    v_lshlrev_b32 v172, 16, v172
    v_lshlrev_b32 v179, 16, v179
    v_lshlrev_b32 v166, 16, v166
    v_lshlrev_b32 v173, 16, v173
    v_lshlrev_b32 v180, 16, v180
    v_lshlrev_b32 v181, 16, v181
    v_mov_b32 v12, v10
    v_mov_b32 v13, v11
    v_add_f32 v42, v2, v3
    v_mul_f32 v43, v2, v2
    v_fmac_f32 v43, v3, v3
    v_add_f32 v42, v42, v4
    v_fmac_f32 v43, v4, v4
    v_add_f32 v42, v42, v5
    v_fmac_f32 v43, v5, v5
    v_add_f32 v42, v42, v6
    v_fmac_f32 v43, v6, v6
    v_add_f32 v42, v42, v7
    v_fmac_f32 v43, v7, v7
    v_add_f32 v42, v42, v8
    v_fmac_f32 v43, v8, v8
    v_add_f32 v42, v42, v9
    v_fmac_f32 v43, v9, v9
    s_nop 0
    v_add_f32_dpp v42, v42, v42 quad_perm:[1,0,3,2] row_mask:0xf bank_mask:0xf
    v_add_f32_dpp v43, v43, v43 quad_perm:[1,0,3,2] row_mask:0xf bank_mask:0xf
    s_nop 0
    v_add_f32_dpp v42, v42, v42 quad_perm:[2,3,0,1] row_mask:0xf bank_mask:0xf
    v_add_f32_dpp v43, v43, v43 quad_perm:[2,3,0,1] row_mask:0xf bank_mask:0xf
    s_nop 0
    v_add_f32_dpp v42, v42, v42 row_ror:4 row_mask:0xf bank_mask:0xf
    v_add_f32_dpp v43, v43, v43 row_ror:4 row_mask:0xf bank_mask:0xf
    s_nop 0
    v_add_f32_dpp v42, v42, v42 row_ror:8 row_mask:0xf bank_mask:0xf
    v_add_f32_dpp v43, v43, v43 row_ror:8 row_mask:0xf bank_mask:0xf
    v_mov_b32 v44, v42
    v_mov_b32 v45, v43
    s_nop 0
    v_permlane16_swap_b32 v44, v42
    v_permlane16_swap_b32 v45, v43
    s_nop 0
    v_add_f32 v42, v42, v44
    v_add_f32 v43, v43, v45
    v_mov_b32 v44, v42
    v_mov_b32 v45, v43
    s_nop 0
    v_permlane32_swap_b32 v44, v42
    v_permlane32_swap_b32 v45, v43
    s_nop 0
    v_add_f32 v42, v42, v44
    v_add_f32 v43, v43, v45
    v_mul_f32 v42, 0x3b000000, v42
    v_mul_f32 v43, 0x3b000000, v43
    v_fma_f32 v43, -v42, v42, v43
    v_max_f32 v43, 0, v43
    v_cvt_pk_bf16_f32 v44, v42, v43
    v_lshlrev_b32 v42, 16, v44
    v_and_b32 v43, 0xffff0000, v44
    v_add_f32 v43, 0x3727c5ac, v43
    v_cvt_pk_bf16_f32 v44, v43, v43
    v_lshlrev_b32 v43, 16, v44
    v_sqrt_f32 v43, v43
    s_nop 0
    v_cvt_pk_bf16_f32 v44, v43, v43
    v_lshlrev_b32 v43, 16, v44
    v_rcp_f32 v15, v43
    v_mov_b32 v14, v42
    s_nop 0
    v_pk_add_f32 v[2:3], v[2:3], v[14:15] op_sel:[0,0] op_sel_hi:[1,0] neg_lo:[0,1] neg_hi:[0,1]
    v_cvt_pk_bf16_f32 v42, v2, v3
    v_lshlrev_b32 v2, 16, v42
    v_and_b32 v3, 0xffff0000, v42
    v_pk_mul_f32 v[2:3], v[2:3], v[14:15] op_sel:[0,1] op_sel_hi:[1,1]
    v_cvt_pk_bf16_f32 v42, v2, v3
    v_lshlrev_b32 v2, 16, v42
    v_and_b32 v3, 0xffff0000, v42
    v_pk_add_f32 v[4:5], v[4:5], v[14:15] op_sel:[0,0] op_sel_hi:[1,0] neg_lo:[0,1] neg_hi:[0,1]
    v_cvt_pk_bf16_f32 v42, v4, v5
    v_lshlrev_b32 v4, 16, v42
    v_and_b32 v5, 0xffff0000, v42
    v_pk_mul_f32 v[4:5], v[4:5], v[14:15] op_sel:[0,1] op_sel_hi:[1,1]
    v_cvt_pk_bf16_f32 v42, v4, v5
    v_lshlrev_b32 v4, 16, v42
    v_and_b32 v5, 0xffff0000, v42
    v_pk_add_f32 v[6:7], v[6:7], v[14:15] op_sel:[0,0] op_sel_hi:[1,0] neg_lo:[0,1] neg_hi:[0,1]
    v_cvt_pk_bf16_f32 v42, v6, v7
    v_lshlrev_b32 v6, 16, v42
    v_and_b32 v7, 0xffff0000, v42
    v_pk_mul_f32 v[6:7], v[6:7], v[14:15] op_sel:[0,1] op_sel_hi:[1,1]
    v_cvt_pk_bf16_f32 v42, v6, v7
    v_lshlrev_b32 v6, 16, v42
    v_and_b32 v7, 0xffff0000, v42
    v_pk_add_f32 v[8:9], v[8:9], v[14:15] op_sel:[0,0] op_sel_hi:[1,0] neg_lo:[0,1] neg_hi:[0,1]
    v_cvt_pk_bf16_f32 v42, v8, v9
    v_lshlrev_b32 v8, 16, v42
    v_and_b32 v9, 0xffff0000, v42
    v_pk_mul_f32 v[8:9], v[8:9], v[14:15] op_sel:[0,1] op_sel_hi:[1,1]
    v_cvt_pk_bf16_f32 v42, v8, v9
    v_lshlrev_b32 v8, 16, v42
    v_and_b32 v9, 0xffff0000, v42
    v_pk_add_f32 v[10:11], v[10:11], v[14:15] op_sel:[0,0] op_sel_hi:[1,0] neg_lo:[0,1] neg_hi:[0,1]
    v_cvt_pk_bf16_f32 v42, v10, v11
    v_lshlrev_b32 v10, 16, v42
    v_and_b32 v11, 0xffff0000, v42
    v_pk_mul_f32 v[10:11], v[10:11], v[14:15] op_sel:[0,1] op_sel_hi:[1,1]
    v_cvt_pk_bf16_f32 v42, v10, v11
    v_lshlrev_b32 v10, 16, v42
    v_and_b32 v11, 0xffff0000, v42
    v_add_f32 v42, v2, v3
    v_mul_f32 v43, v2, v2
    v_fmac_f32 v43, v3, v3
    v_add_f32 v42, v42, v4
    v_fmac_f32 v43, v4, v4
    v_add_f32 v42, v42, v5
    v_fmac_f32 v43, v5, v5
    v_add_f32 v42, v42, v6
    v_fmac_f32 v43, v6, v6
    v_add_f32 v42, v42, v7
    v_fmac_f32 v43, v7, v7
    v_add_f32 v42, v42, v8
    v_fmac_f32 v43, v8, v8
    v_add_f32 v42, v42, v9
    v_fmac_f32 v43, v9, v9
    s_nop 0
    v_add_f32_dpp v42, v42, v42 quad_perm:[1,0,3,2] row_mask:0xf bank_mask:0xf
    v_add_f32_dpp v43, v43, v43 quad_perm:[1,0,3,2] row_mask:0xf bank_mask:0xf
    s_nop 0
    v_add_f32_dpp v42, v42, v42 quad_perm:[2,3,0,1] row_mask:0xf bank_mask:0xf
    v_add_f32_dpp v43, v43, v43 quad_perm:[2,3,0,1] row_mask:0xf bank_mask:0xf
    s_nop 0
    v_add_f32_dpp v42, v42, v42 row_ror:4 row_mask:0xf bank_mask:0xf
    v_add_f32_dpp v43, v43, v43 row_ror:4 row_mask:0xf bank_mask:0xf
    s_nop 0
    v_add_f32_dpp v42, v42, v42 row_ror:8 row_mask:0xf bank_mask:0xf
    v_add_f32_dpp v43, v43, v43 row_ror:8 row_mask:0xf bank_mask:0xf
    v_mov_b32 v44, v42
    v_mov_b32 v45, v43
    s_nop 0
    v_permlane16_swap_b32 v44, v42
    v_permlane16_swap_b32 v45, v43
    s_nop 0
    v_add_f32 v42, v42, v44
    v_add_f32 v43, v43, v45
    v_mov_b32 v44, v42
    v_mov_b32 v45, v43
    s_nop 0
    v_permlane32_swap_b32 v44, v42
    v_permlane32_swap_b32 v45, v43
    s_nop 0
    v_add_f32 v42, v42, v44
    v_add_f32 v43, v43, v45
    v_mul_f32 v42, 0x3b000000, v42
    v_mul_f32 v43, 0x3b000000, v43
    v_fma_f32 v43, -v42, v42, v43
    v_max_f32 v43, 0, v43
    v_cvt_pk_bf16_f32 v44, v42, v43
    v_lshlrev_b32 v42, 16, v44
    v_and_b32 v43, 0xffff0000, v44
    v_add_f32 v43, 0x3727c5ac, v43
    v_cvt_pk_bf16_f32 v44, v43, v43
    v_lshlrev_b32 v43, 16, v44
    v_sqrt_f32 v43, v43
    s_nop 0
    v_cvt_pk_bf16_f32 v44, v43, v43
    v_lshlrev_b32 v43, 16, v44
    v_rcp_f32 v15, v43
    v_mov_b32 v14, v42
    s_nop 0
    v_pk_add_f32 v[10:11], v[10:11], v[14:15] op_sel:[0,0] op_sel_hi:[1,0] neg_lo:[0,1] neg_hi:[0,1]
    v_cvt_pk_bf16_f32 v42, v10, v11
    v_lshlrev_b32 v10, 16, v42
    v_and_b32 v11, 0xffff0000, v42
    v_pk_mul_f32 v[10:11], v[10:11], v[14:15] op_sel:[0,1] op_sel_hi:[1,1]
    v_cvt_pk_bf16_f32 v42, v10, v11
    v_lshlrev_b32 v10, 16, v42
    v_and_b32 v11, 0xffff0000, v42
    s_mov_b32 s54, 0xc0135761
    s_mov_b32 s55, 0xbdd2d3e8
    v_mov_b32 v16, 0
    v_mov_b32 v17, 0
    v_mov_b32 v30, s54
    v_mov_b32 v31, s55
    v_mov_b32 v32, 1.0
    v_pk_mul_f32 v[200:201], v[10:11], v[160:161] op_sel:[0,0] op_sel_hi:[1,0]
    v_pk_mul_f32 v[202:203], v[10:11], v[160:161] op_sel:[0,1] op_sel_hi:[1,1]
    v_pk_mul_f32 v[204:205], v[10:11], v[162:163] op_sel:[0,0] op_sel_hi:[1,0]
    v_pk_mul_f32 v[206:207], v[10:11], v[162:163] op_sel:[0,1] op_sel_hi:[1,1]
    v_pk_mul_f32 v[208:209], v[10:11], v[164:165] op_sel:[0,0] op_sel_hi:[1,0]
    v_pk_mul_f32 v[210:211], v[10:11], v[164:165] op_sel:[0,1] op_sel_hi:[1,1]
    v_pk_mul_f32 v[212:213], v[10:11], v[166:167] op_sel:[0,0] op_sel_hi:[1,0]
    v_cvt_pk_bf16_f32 v24, v200, v201
    v_lshlrev_b32 v200, 16, v24
    v_and_b32 v201, 0xffff0000, v24
    v_cvt_pk_bf16_f32 v24, v202, v203
    v_lshlrev_b32 v202, 16, v24
    v_and_b32 v203, 0xffff0000, v24
    v_cvt_pk_bf16_f32 v24, v204, v205
    v_lshlrev_b32 v204, 16, v24
    v_and_b32 v205, 0xffff0000, v24
    v_cvt_pk_bf16_f32 v24, v206, v207
    v_lshlrev_b32 v206, 16, v24
    v_and_b32 v207, 0xffff0000, v24
    v_cvt_pk_bf16_f32 v24, v208, v209
    v_lshlrev_b32 v208, 16, v24
    v_and_b32 v209, 0xffff0000, v24
    v_cvt_pk_bf16_f32 v24, v210, v211
    v_lshlrev_b32 v210, 16, v24
    v_and_b32 v211, 0xffff0000, v24
    v_cvt_pk_bf16_f32 v24, v212, v213
    v_lshlrev_b32 v212, 16, v24
    v_and_b32 v213, 0xffff0000, v24
    v_pk_add_f32 v[200:201], v[200:201], v[166:167] op_sel:[0,1] op_sel_hi:[1,1]
    v_pk_add_f32 v[202:203], v[202:203], v[168:169] op_sel:[0,0] op_sel_hi:[1,0]
    v_pk_add_f32 v[204:205], v[204:205], v[168:169] op_sel:[0,1] op_sel_hi:[1,1]
    v_pk_add_f32 v[206:207], v[206:207], v[170:171] op_sel:[0,0] op_sel_hi:[1,0]
    v_pk_add_f32 v[208:209], v[208:209], v[170:171] op_sel:[0,1] op_sel_hi:[1,1]
    v_pk_add_f32 v[210:211], v[210:211], v[172:173] op_sel:[0,0] op_sel_hi:[1,0]
    v_pk_add_f32 v[212:213], v[212:213], v[172:173] op_sel:[0,1] op_sel_hi:[1,1]
    v_cvt_pk_bf16_f32 v24, v200, v201
    v_lshlrev_b32 v200, 16, v24
    v_and_b32 v201, 0xffff0000, v24
    v_cvt_pk_bf16_f32 v24, v202, v203
    v_lshlrev_b32 v202, 16, v24
    v_and_b32 v203, 0xffff0000, v24
    v_cvt_pk_bf16_f32 v24, v204, v205
    v_lshlrev_b32 v204, 16, v24
    v_and_b32 v205, 0xffff0000, v24
    v_cvt_pk_bf16_f32 v24, v206, v207
    v_lshlrev_b32 v206, 16, v24
    v_and_b32 v207, 0xffff0000, v24
    v_cvt_pk_bf16_f32 v24, v208, v209
    v_lshlrev_b32 v208, 16, v24
    v_and_b32 v209, 0xffff0000, v24
    v_cvt_pk_bf16_f32 v24, v210, v211
    v_lshlrev_b32 v210, 16, v24
    v_and_b32 v211, 0xffff0000, v24
    v_cvt_pk_bf16_f32 v24, v212, v213
    v_lshlrev_b32 v212, 16, v24
    v_and_b32 v213, 0xffff0000, v24
    v_pk_mul_f32 v[216:217], v[200:201], v[200:201]
    v_pk_mul_f32 v[218:219], v[202:203], v[202:203]
    v_pk_mul_f32 v[220:221], v[204:205], v[204:205]
    v_pk_mul_f32 v[222:223], v[206:207], v[206:207]
    v_pk_mul_f32 v[224:225], v[208:209], v[208:209]
    v_pk_mul_f32 v[226:227], v[210:211], v[210:211]
    v_pk_mul_f32 v[228:229], v[212:213], v[212:213]
    v_pk_fma_f32 v[216:217], v[216:217], v[30:31], v[30:31] op_sel:[0,1,0] op_sel_hi:[1,1,0]
    v_pk_fma_f32 v[218:219], v[218:219], v[30:31], v[30:31] op_sel:[0,1,0] op_sel_hi:[1,1,0]
    v_pk_fma_f32 v[220:221], v[220:221], v[30:31], v[30:31] op_sel:[0,1,0] op_sel_hi:[1,1,0]
    v_pk_fma_f32 v[222:223], v[222:223], v[30:31], v[30:31] op_sel:[0,1,0] op_sel_hi:[1,1,0]
    v_pk_fma_f32 v[224:225], v[224:225], v[30:31], v[30:31] op_sel:[0,1,0] op_sel_hi:[1,1,0]
    v_pk_fma_f32 v[226:227], v[226:227], v[30:31], v[30:31] op_sel:[0,1,0] op_sel_hi:[1,1,0]
    v_pk_fma_f32 v[228:229], v[228:229], v[30:31], v[30:31] op_sel:[0,1,0] op_sel_hi:[1,1,0]
    v_pk_mul_f32 v[216:217], v[216:217], v[200:201]
    v_pk_mul_f32 v[218:219], v[218:219], v[202:203]
    v_pk_mul_f32 v[220:221], v[220:221], v[204:205]
    v_pk_mul_f32 v[222:223], v[222:223], v[206:207]
    v_pk_mul_f32 v[224:225], v[224:225], v[208:209]
    v_pk_mul_f32 v[226:227], v[226:227], v[210:211]
    v_pk_mul_f32 v[228:229], v[228:229], v[212:213]
    v_exp_f32 v216, v216
    v_exp_f32 v217, v217
    v_exp_f32 v218, v218
    v_exp_f32 v219, v219
    v_exp_f32 v220, v220
    v_exp_f32 v221, v221
    v_exp_f32 v222, v222
    v_exp_f32 v223, v223
    v_exp_f32 v224, v224
    v_exp_f32 v225, v225
    v_exp_f32 v226, v226
    v_exp_f32 v227, v227
    v_exp_f32 v228, v228
    v_exp_f32 v229, v229
    v_pk_add_f32 v[216:217], v[216:217], v[32:33] op_sel:[0,0] op_sel_hi:[1,0]
    v_pk_add_f32 v[218:219], v[218:219], v[32:33] op_sel:[0,0] op_sel_hi:[1,0]
    v_pk_add_f32 v[220:221], v[220:221], v[32:33] op_sel:[0,0] op_sel_hi:[1,0]
    v_pk_add_f32 v[222:223], v[222:223], v[32:33] op_sel:[0,0] op_sel_hi:[1,0]
    v_pk_add_f32 v[224:225], v[224:225], v[32:33] op_sel:[0,0] op_sel_hi:[1,0]
    v_pk_add_f32 v[226:227], v[226:227], v[32:33] op_sel:[0,0] op_sel_hi:[1,0]
    v_pk_add_f32 v[228:229], v[228:229], v[32:33] op_sel:[0,0] op_sel_hi:[1,0]
    v_rcp_f32 v216, v216
    v_rcp_f32 v217, v217
    v_rcp_f32 v218, v218
    v_rcp_f32 v219, v219
    v_rcp_f32 v220, v220
    v_rcp_f32 v221, v221
    v_rcp_f32 v222, v222
    v_rcp_f32 v223, v223
    v_rcp_f32 v224, v224
    v_rcp_f32 v225, v225
    v_rcp_f32 v226, v226
    v_rcp_f32 v227, v227
    v_rcp_f32 v228, v228
    v_rcp_f32 v229, v229
    v_pk_mul_f32 v[200:201], v[200:201], v[216:217]
    v_pk_mul_f32 v[202:203], v[202:203], v[218:219]
    v_pk_mul_f32 v[204:205], v[204:205], v[220:221]
    v_pk_mul_f32 v[206:207], v[206:207], v[222:223]
    v_pk_mul_f32 v[208:209], v[208:209], v[224:225]
    v_pk_mul_f32 v[210:211], v[210:211], v[226:227]
    v_pk_mul_f32 v[212:213], v[212:213], v[228:229]
    v_cvt_pk_bf16_f32 v24, v200, v201
    v_lshlrev_b32 v200, 16, v24
    v_and_b32 v201, 0xffff0000, v24
    v_cvt_pk_bf16_f32 v24, v202, v203
    v_lshlrev_b32 v202, 16, v24
    v_and_b32 v203, 0xffff0000, v24
    v_cvt_pk_bf16_f32 v24, v204, v205
    v_lshlrev_b32 v204, 16, v24
    v_and_b32 v205, 0xffff0000, v24
    v_cvt_pk_bf16_f32 v24, v206, v207
    v_lshlrev_b32 v206, 16, v24
    v_and_b32 v207, 0xffff0000, v24
    v_cvt_pk_bf16_f32 v24, v208, v209
    v_lshlrev_b32 v208, 16, v24
    v_and_b32 v209, 0xffff0000, v24
    v_cvt_pk_bf16_f32 v24, v210, v211
    v_lshlrev_b32 v210, 16, v24
    v_and_b32 v211, 0xffff0000, v24
    v_cvt_pk_bf16_f32 v24, v212, v213
    v_lshlrev_b32 v212, 16, v24
    v_and_b32 v213, 0xffff0000, v24
    v_pk_fma_f32 v[16:17], v[200:201], v[174:175], v[16:17] op_sel:[0,0,0] op_sel_hi:[1,0,1]
    v_pk_fma_f32 v[16:17], v[202:203], v[174:175], v[16:17] op_sel:[0,1,0] op_sel_hi:[1,1,1]
    v_pk_fma_f32 v[16:17], v[204:205], v[176:177], v[16:17] op_sel:[0,0,0] op_sel_hi:[1,0,1]
    v_pk_fma_f32 v[16:17], v[206:207], v[176:177], v[16:17] op_sel:[0,1,0] op_sel_hi:[1,1,1]
    v_pk_fma_f32 v[16:17], v[208:209], v[178:179], v[16:17] op_sel:[0,0,0] op_sel_hi:[1,0,1]
    v_pk_fma_f32 v[16:17], v[210:211], v[178:179], v[16:17] op_sel:[0,1,0] op_sel_hi:[1,1,1]
    v_pk_fma_f32 v[16:17], v[212:213], v[180:181], v[16:17] op_sel:[0,0,0] op_sel_hi:[1,0,1]
    s_nop 0
    v_add_f32_dpp v16, v16, v16 quad_perm:[1,0,3,2] row_mask:0xf bank_mask:0xf
    v_add_f32_dpp v17, v17, v17 quad_perm:[1,0,3,2] row_mask:0xf bank_mask:0xf
    s_nop 0
    v_add_f32_dpp v16, v16, v16 quad_perm:[2,3,0,1] row_mask:0xf bank_mask:0xf
    v_add_f32_dpp v17, v17, v17 quad_perm:[2,3,0,1] row_mask:0xf bank_mask:0xf
    s_nop 0
    v_add_f32_dpp v16, v16, v16 row_ror:4 row_mask:0xf bank_mask:0xf
    v_add_f32_dpp v17, v17, v17 row_ror:4 row_mask:0xf bank_mask:0xf
    s_nop 0
    v_add_f32_dpp v16, v16, v16 row_ror:8 row_mask:0xf bank_mask:0xf
    v_add_f32_dpp v17, v17, v17 row_ror:8 row_mask:0xf bank_mask:0xf
    v_mov_b32 v40, v16
    v_mov_b32 v41, v17
    s_nop 0
    v_permlane16_swap_b32 v40, v16
    v_permlane16_swap_b32 v41, v17
    s_nop 0
    v_add_f32 v16, v16, v40
    v_add_f32 v17, v17, v41
    v_mov_b32 v40, v16
    v_mov_b32 v41, v17
    s_nop 0
    v_permlane32_swap_b32 v40, v16
    v_permlane32_swap_b32 v41, v17
    s_nop 0
    v_add_f32 v16, v16, v40
    v_add_f32 v17, v17, v41
    s_lshl_b32 s42, s32, 3
    v_mov_b32 v40, s42
    ds_write_b64 v40, v[16:17] offset:33920
    s_waitcnt lgkmcnt(0)
    s_barrier
    s_cmp_eq_u32 s32, 0
    s_cbranch_scc0 w0_22
    v_mov_b32 v40, 0
    ds_read_b128 v[2:5], v40 offset:33920
    ds_read_b128 v[6:9], v40 offset:33936
    s_waitcnt lgkmcnt(0)
    v_add_f32 v2, v2, v4
    v_add_f32 v3, v3, v5
    v_add_f32 v2, v2, v6
    v_add_f32 v3, v3, v7
    v_add_f32 v2, v2, v8
    v_add_f32 v3, v3, v9
    v_cvt_pk_bf16_f32 v40, v2, v3
    v_lshlrev_b32 v2, 16, v40
    v_and_b32 v3, 0xffff0000, v40
    v_add_f32 v2, v2, v181
    v_add_f32 v3, v3, v181
    v_cvt_pk_bf16_f32 v40, v2, v3
    v_lshlrev_b32 v2, 16, v40
    v_and_b32 v3, 0xffff0000, v40
    v_add_f32 v2, v12, v2
    v_add_f32 v3, v13, v3
    v_cvt_pk_bf16_f32 v40, v2, v3
    v_lshlrev_b32 v2, 16, v40
    v_and_b32 v3, 0xffff0000, v40
    s_lshl_b32 s42, s2, 6
    s_add_u32 s42, s42, 0x144000
    v_mov_b32 v40, s42
    v_cmp_eq_u32 vcc, 0, v1
    s_and_saveexec_b64 s[50:51], vcc
    global_store_dwordx2 v40, v[2:3], s[40:41] sc1
    s_mov_b64 exec, s[50:51]
    s_mov_b32 s35, 0x8000
poll_23:
    global_load_dwordx2 v[182:183], v189, s[40:41] sc1
pollc_25:
    s_waitcnt vmcnt(0)
    v_max_u32 v40, v182, v183
    v_cmp_eq_u32 vcc, -1, v40
    s_cbranch_vccz polld_24
    s_sub_u32 s35, s35, 1
    s_cbranch_scc0 poll_23
polld_24:
    s_lshl_b32 s42, s31, 6
    s_add_u32 s42, s42, 11264
    v_lshlrev_b32 v40, 3, v1
    v_add_u32 v40, s42, v40
    v_cmp_gt_u32 vcc, 8, v1
    s_and_saveexec_b64 s[50:51], vcc
    s_cmp_eq_u32 s34, 0
    s_cbranch_scc0 sl_26
    global_store_dwordx2 v40, v[182:183], s[36:37]
    s_branch sld_27
sl_26:
    global_store_dwordx2 v40, v[182:183], s[36:37] sc1
sld_27:
    s_mov_b64 exec, s[50:51]
    v_lshlrev_b32 v41, 5, v1
    v_add_u32 v40, 11264, v41
    s_mov_b32 s35, 0x8000
poll_28:
    global_load_dwordx4 v[2:5], v40, s[36:37] sc1
    global_load_dwordx4 v[6:9], v40, s[36:37] offset:16 sc1
pollc_30:
    s_waitcnt vmcnt(0)
    v_max3_u32 v42, v2, v3, v4
    v_max3_u32 v42, v42, v5, v6
    v_max3_u32 v42, v42, v7, v8
    v_max_u32 v42, v42, v9
    v_cmp_eq_u32 vcc, -1, v42
    s_cbranch_vccz polld_29
    s_sub_u32 s35, s35, 1
    s_cbranch_scc0 poll_28
polld_29:
    ds_write_b128 v41, v[2:5] offset:16384
    ds_write_b128 v41, v[6:9] offset:16400
    s_waitcnt lgkmcnt(0)
w0_22:
    s_barrier
    v_lshrrev_b32 v47, 4, v1
    v_and_b32 v48, 15, v1
    v_lshrrev_b32 v49, 2, v48
    v_lshl_add_u32 v47, v47, 3, v49
    v_lshlrev_b32 v47, 7, v47
    v_and_b32 v48, 3, v48
    v_lshl_add_u32 v47, v48, 3, v47
    s_lshl_b32 s42, s32, 5
    v_add_u32 v47, s42, v47
    ds_read_b64_tr_b16 v[128:129], v47 offset:36864
    ds_read_b64_tr_b16 v[130:131], v47 offset:37376
    ds_read_b64_tr_b16 v[132:133], v47 offset:40960
    ds_read_b64_tr_b16 v[134:135], v47 offset:41472
    ds_read_b64_tr_b16 v[136:137], v47 offset:45056
    ds_read_b64_tr_b16 v[138:139], v47 offset:45568
    ds_read_b64_tr_b16 v[140:141], v47 offset:49152
    ds_read_b64_tr_b16 v[142:143], v47 offset:49664
    v_lshlrev_b32 v40, 5, v1
    ds_read_b128 v[24:27], v40 offset:16384
    ds_read_b128 v[28:31], v40 offset:16400
    ds_read_b64 v[32:33], v190 offset:16384
    s_waitcnt lgkmcnt(0)
    s_add_u32 s40, s28, 1572864
    s_addc_u32 s41, s29, 0
    s_mul_i32 s42, s30, 163840
    s_add_u32 s36, s40, s42
    s_addc_u32 s37, s41, 0
    v_add_f32 v42, v24, v25
    v_mul_f32 v43, v24, v24
    v_fmac_f32 v43, v25, v25
    v_add_f32 v42, v42, v26
    v_fmac_f32 v43, v26, v26
    v_add_f32 v42, v42, v27
    v_fmac_f32 v43, v27, v27
    v_add_f32 v42, v42, v28
    v_fmac_f32 v43, v28, v28
    v_add_f32 v42, v42, v29
    v_fmac_f32 v43, v29, v29
    v_add_f32 v42, v42, v30
    v_fmac_f32 v43, v30, v30
    v_add_f32 v42, v42, v31
    v_fmac_f32 v43, v31, v31
    s_nop 0
    v_add_f32_dpp v42, v42, v42 quad_perm:[1,0,3,2] row_mask:0xf bank_mask:0xf
    v_add_f32_dpp v43, v43, v43 quad_perm:[1,0,3,2] row_mask:0xf bank_mask:0xf
    s_nop 0
    v_add_f32_dpp v42, v42, v42 quad_perm:[2,3,0,1] row_mask:0xf bank_mask:0xf
    v_add_f32_dpp v43, v43, v43 quad_perm:[2,3,0,1] row_mask:0xf bank_mask:0xf
    s_nop 0
    v_add_f32_dpp v42, v42, v42 row_ror:4 row_mask:0xf bank_mask:0xf
    v_add_f32_dpp v43, v43, v43 row_ror:4 row_mask:0xf bank_mask:0xf
    s_nop 0
    v_add_f32_dpp v42, v42, v42 row_ror:8 row_mask:0xf bank_mask:0xf
    v_add_f32_dpp v43, v43, v43 row_ror:8 row_mask:0xf bank_mask:0xf
    v_mov_b32 v44, v42
    v_mov_b32 v45, v43
    s_nop 0
    v_permlane16_swap_b32 v44, v42
    v_permlane16_swap_b32 v45, v43
    s_nop 0
    v_add_f32 v42, v42, v44
    v_add_f32 v43, v43, v45
    v_mov_b32 v44, v42
    v_mov_b32 v45, v43
    s_nop 0
    v_permlane32_swap_b32 v44, v42
    v_permlane32_swap_b32 v45, v43
    s_nop 0
    v_add_f32 v42, v42, v44
    v_add_f32 v43, v43, v45
    v_mul_f32 v42, 0x3b000000, v42
    v_mul_f32 v43, 0x3b000000, v43
    v_fma_f32 v43, -v42, v42, v43
    v_max_f32 v43, 0, v43
    v_cvt_pk_bf16_f32 v44, v42, v43
    v_lshlrev_b32 v42, 16, v44
    v_and_b32 v43, 0xffff0000, v44
    v_add_f32 v43, 0x3727c5ac, v43
    v_cvt_pk_bf16_f32 v44, v43, v43
    v_lshlrev_b32 v43, 16, v44
    v_sqrt_f32 v43, v43
    s_nop 0
    v_cvt_pk_bf16_f32 v44, v43, v43
    v_lshlrev_b32 v43, 16, v44
    v_rcp_f32 v41, v43
    v_mov_b32 v40, v42
    s_nop 0
    v_pk_add_f32 v[32:33], v[32:33], v[40:41] op_sel:[0,0] op_sel_hi:[1,0] neg_lo:[0,1] neg_hi:[0,1]
    v_cvt_pk_bf16_f32 v42, v32, v33
    v_lshlrev_b32 v32, 16, v42
    v_and_b32 v33, 0xffff0000, v42
    v_pk_mul_f32 v[32:33], v[32:33], v[40:41] op_sel:[0,1] op_sel_hi:[1,1]
    v_cvt_pk_bf16_f32 v42, v32, v33
    v_lshlrev_b32 v32, 16, v42
    v_and_b32 v33, 0xffff0000, v42
    v_cvt_pk_bf16_f32 v46, v32, v33
    s_lshl_b32 s42, s32, 8
    v_lshlrev_b32 v47, 2, v1
    v_add_u32 v47, s42, v47
    ds_write_b32 v47, v46 offset:34816
    v_lshrrev_b32 v48, 4, v1
    v_lshlrev_b32 v48, 4, v48
    v_add_u32 v48, s42, v48
    s_waitcnt lgkmcnt(0)
    ds_read_b128 v[2:5], v48 offset:34816
    ds_read_b128 v[6:9], v48 offset:34880
    ds_read_b128 v[10:13], v48 offset:34944
    ds_read_b128 v[14:17], v48 offset:35008
    s_lshr_b32 s42, s31, 3
    s_lshl_b32 s42, s42, 11
    s_and_b32 s43, s31, 7
    s_lshl_b32 s43, s43, 8
    s_add_u32 s42, s42, s43
    s_lshl_b32 s43, s32, 6
    s_add_u32 s42, s42, s43
    v_lshlrev_b32 v49, 2, v1
    v_add_u32 v49, s42, v49
    s_waitcnt lgkmcnt(0)
    v_mfma_f32_16x16x32_bf16 v[52:55], v[2:5], v[128:131], 0
    v_mfma_f32_16x16x32_bf16 v[52:55], v[6:9], v[132:135], v[52:55]
    v_mfma_f32_16x16x32_bf16 v[52:55], v[10:13], v[136:139], v[52:55]
    v_mfma_f32_16x16x32_bf16 v[52:55], v[14:17], v[140:143], v[52:55]
    v_cmp_gt_u32 vcc, 16, v1
    s_and_saveexec_b64 s[50:51], vcc
    s_nop 7
    s_cmp_eq_u32 s34, 0
    s_cbranch_scc0 sl_31
    global_store_dword v49, v52, s[36:37]
    s_branch sld_32
sl_31:
    global_store_dword v49, v52, s[36:37] sc1
sld_32:
    s_mov_b64 exec, s[50:51]
    v_add_u32 v60, 4096, v185
    s_mov_b32 s35, 0x8000
poll_33:
    global_load_dwordx2 v[2:3], v185, s[36:37] offset:0 sc1
    global_load_dwordx2 v[4:5], v185, s[36:37] offset:2048 sc1
    global_load_dwordx2 v[6:7], v60, s[36:37] offset:0 sc1
    global_load_dwordx2 v[8:9], v60, s[36:37] offset:2048 sc1
pollc_35:
    s_waitcnt vmcnt(0)
    v_max3_u32 v40, v2, v3, v4
    v_max3_u32 v40, v40, v5, v6
    v_max3_u32 v40, v40, v7, v8
    v_max_u32 v40, v40, v9
    v_cmp_eq_u32 vcc, -1, v40
    s_cbranch_vccz polld_34
    s_sub_u32 s35, s35, 1
    s_cbranch_scc0 poll_33
polld_34:
    v_add_f32 v2, v2, v4
    v_add_f32 v3, v3, v5
    v_add_f32 v2, v2, v6
    v_add_f32 v3, v3, v7
    v_add_f32 v2, v2, v8
    v_add_f32 v3, v3, v9
    v_cvt_pk_bf16_f32 v40, v2, v3
    v_lshlrev_b32 v41, 2, v1
    s_mul_i32 s42, s32, 272
    v_add_u32 v41, s42, v41
    ds_write_b32 v41, v40 offset:32768
    s_waitcnt lgkmcnt(0)
    s_barrier
    v_and_b32 v40, 3, v1
    v_mul_u32_u24 v40, 272, v40
    v_lshrrev_b32 v41, 4, v1
    v_lshl_add_u32 v40, v41, 4, v40
    ds_read_b128 v[2:5], v40 offset:32768
    ds_read_b128 v[6:9], v40 offset:32832
    ds_read_b128 v[10:13], v40 offset:32896
    ds_read_b128 v[14:17], v40 offset:32960
    s_mov_b32 s52, 0x3db504f3
    s_mov_b32 s53, 0x3fb8aa3b
    s_waitcnt lgkmcnt(0)
    s_nop 0
    v_mfma_f32_16x16x32_bf16 v[24:27], v[64:67], v[2:5], 0
    v_mfma_f32_16x16x32_bf16 v[28:31], v[80:83], v[2:5], 0
    v_mfma_f32_16x16x32_bf16 v[24:27], v[68:71], v[6:9], v[24:27]
    v_mfma_f32_16x16x32_bf16 v[28:31], v[84:87], v[6:9], v[28:31]
    v_mfma_f32_16x16x32_bf16 v[24:27], v[72:75], v[10:13], v[24:27]
    v_mfma_f32_16x16x32_bf16 v[28:31], v[88:91], v[10:13], v[28:31]
    v_mfma_f32_16x16x32_bf16 v[24:27], v[76:79], v[14:17], v[24:27]
    v_mfma_f32_16x16x32_bf16 v[28:31], v[92:95], v[14:17], v[28:31]
    v_and_b32 v40, 3, v1
    v_mul_u32_u24 v42, 576, v40
    v_lshl_add_u32 v42, v41, 4, v42
    v_bfe_u32 v40, v1, 2, 2
    v_lshl_add_u32 v42, v40, 7, v42
    s_mul_i32 s42, s32, 2304
    v_add_u32 v42, s42, v42
    s_lshl_b32 s42, s32, 3
    v_lshlrev_b32 v43, 5, v1
    v_add_u32 v43, s42, v43
    s_nop 2
    v_cvt_pk_bf16_f32 v44, v24, v25
    v_lshlrev_b32 v24, 16, v44
    v_and_b32 v25, 0xffff0000, v44
    v_mul_f32 v24, s52, v24
    v_mul_f32 v25, s52, v25
    v_cvt_pk_bf16_f32 v44, v24, v25
    v_lshlrev_b32 v24, 16, v44
    v_and_b32 v25, 0xffff0000, v44
    v_cvt_pk_bf16_f32 v44, v26, v27
    v_lshlrev_b32 v26, 16, v44
    v_and_b32 v27, 0xffff0000, v44
    v_mul_f32 v26, s52, v26
    v_mul_f32 v27, s52, v27
    v_cvt_pk_bf16_f32 v44, v26, v27
    v_lshlrev_b32 v26, 16, v44
    v_and_b32 v27, 0xffff0000, v44
    v_cvt_pk_bf16_f32 v44, v28, v29
    v_lshlrev_b32 v28, 16, v44
    v_and_b32 v29, 0xffff0000, v44
    v_mul_f32 v28, s52, v28
    v_mul_f32 v29, s52, v29
    v_cvt_pk_bf16_f32 v44, v28, v29
    v_lshlrev_b32 v28, 16, v44
    v_and_b32 v29, 0xffff0000, v44
    v_cvt_pk_bf16_f32 v44, v30, v31
    v_lshlrev_b32 v30, 16, v44
    v_and_b32 v31, 0xffff0000, v44
    v_mul_f32 v30, s52, v30
    v_mul_f32 v31, s52, v31
    v_cvt_pk_bf16_f32 v44, v30, v31
    v_lshlrev_b32 v30, 16, v44
    v_and_b32 v31, 0xffff0000, v44
    v_max3_f32 v34, v24, v25, v26
    v_max3_f32 v34, v34, v27, v28
    v_max3_f32 v34, v34, v29, v30
    v_max_f32 v34, v34, v31
    v_mov_b32 v44, v34
    s_nop 1
    v_permlane16_swap_b32 v44, v34
    s_nop 0
    v_max_f32 v34, v34, v44
    v_mov_b32 v44, v34
    s_nop 1
    v_permlane32_swap_b32 v44, v34
    s_nop 0
    v_max_f32 v34, v34, v44
    v_mul_f32 v45, s53, v34
    v_fma_f32 v24, v24, s53, -v45
    v_fma_f32 v25, v25, s53, -v45
    v_fma_f32 v26, v26, s53, -v45
    v_fma_f32 v27, v27, s53, -v45
    v_fma_f32 v28, v28, s53, -v45
    v_fma_f32 v29, v29, s53, -v45
    v_fma_f32 v30, v30, s53, -v45
    v_fma_f32 v31, v31, s53, -v45
    v_exp_f32 v24, v24
    v_exp_f32 v25, v25
    v_exp_f32 v26, v26
    v_exp_f32 v27, v27
    v_exp_f32 v28, v28
    v_exp_f32 v29, v29
    v_exp_f32 v30, v30
    v_exp_f32 v31, v31
    s_nop 0
    v_cvt_pk_bf16_f32 v36, v24, v25
    v_cvt_pk_bf16_f32 v37, v26, v27
    v_cvt_pk_bf16_f32 v38, v28, v29
    v_cvt_pk_bf16_f32 v39, v30, v31
    v_add_f32 v35, v24, v25
    v_add_f32 v35, v35, v26
    v_mfma_f32_16x16x32_bf16 v[200:203], v[96:99], v[36:39], 0
    v_mfma_f32_16x16x32_bf16 v[204:207], v[100:103], v[36:39], 0
    v_mfma_f32_16x16x32_bf16 v[208:211], v[104:107], v[36:39], 0
    v_mfma_f32_16x16x32_bf16 v[212:215], v[108:111], v[36:39], 0
    v_mfma_f32_16x16x32_bf16 v[216:219], v[112:115], v[36:39], 0
    v_mfma_f32_16x16x32_bf16 v[220:223], v[116:119], v[36:39], 0
    v_mfma_f32_16x16x32_bf16 v[224:227], v[120:123], v[36:39], 0
    v_mfma_f32_16x16x32_bf16 v[228:231], v[124:127], v[36:39], 0
    v_add_f32 v35, v35, v27
    v_add_f32 v35, v35, v28
    v_add_f32 v35, v35, v29
    v_add_f32 v35, v35, v30
    v_add_f32 v35, v35, v31
    v_mov_b32 v44, v35
    s_nop 1
    v_permlane16_swap_b32 v44, v35
    s_nop 0
    v_add_f32 v35, v35, v44
    v_mov_b32 v44, v35
    s_nop 1
    v_permlane32_swap_b32 v44, v35
    s_nop 0
    v_add_f32 v35, v35, v44
    s_nop 3
    v_cndmask_b32 v2, v200, v208, s[76:77]
    v_cndmask_b32 v10, v216, v224, s[76:77]
    v_cndmask_b32 v3, v201, v209, s[76:77]
    v_cndmask_b32 v11, v217, v225, s[76:77]
    v_cndmask_b32 v4, v202, v210, s[76:77]
    v_cndmask_b32 v12, v218, v226, s[76:77]
    v_cndmask_b32 v5, v203, v211, s[76:77]
    v_cndmask_b32 v13, v219, v227, s[76:77]
    v_cndmask_b32 v6, v204, v212, s[76:77]
    v_cndmask_b32 v14, v220, v228, s[76:77]
    v_cndmask_b32 v7, v205, v213, s[76:77]
    v_cndmask_b32 v15, v221, v229, s[76:77]
    v_cndmask_b32 v8, v206, v214, s[76:77]
    v_cndmask_b32 v16, v222, v230, s[76:77]
    v_cndmask_b32 v9, v207, v215, s[76:77]
    v_cndmask_b32 v17, v223, v231, s[76:77]
    v_cndmask_b32 v2, v2, v10, s[78:79]
    v_cndmask_b32 v3, v3, v11, s[78:79]
    v_cndmask_b32 v4, v4, v12, s[78:79]
    v_cndmask_b32 v5, v5, v13, s[78:79]
    v_cndmask_b32 v6, v6, v14, s[78:79]
    v_cndmask_b32 v7, v7, v15, s[78:79]
    v_cndmask_b32 v8, v8, v16, s[78:79]
    v_cndmask_b32 v9, v9, v17, s[78:79]
    ds_write_b128 v42, v[2:5] offset:0
    ds_write_b128 v42, v[6:9] offset:64
    v_cmp_gt_u32 vcc, 4, v1
    s_and_saveexec_b64 s[50:51], vcc
    ds_write_b64 v43, v[34:35] offset:10240
    s_mov_b64 exec, s[50:51]
    s_waitcnt lgkmcnt(0)
    s_barrier
    s_mul_i32 s42, s32, 576
    v_lshlrev_b32 v57, 3, v1
    v_add_u32 v57, s42, v57
    ds_read_b64 v[2:3], v57 offset:0
    ds_read_b64 v[4:5], v57 offset:2304
    ds_read_b64 v[6:7], v57 offset:4608
    ds_read_b64 v[8:9], v57 offset:6912
    s_lshl_b32 s42, s32, 5
    v_mov_b32 v40, s42
    ds_read_b128 v[12:15], v40 offset:10240
    ds_read_b128 v[16:19], v40 offset:10256
    s_waitcnt lgkmcnt(0)
    v_max3_f32 v20, v12, v14, v16
    v_max_f32 v20, v20, v18
    v_sub_f32 v12, v12, v20
    v_sub_f32 v14, v14, v20
    v_sub_f32 v16, v16, v20
    v_sub_f32 v18, v18, v20
    v_mul_f32 v12, s53, v12
    v_mul_f32 v14, s53, v14
    v_mul_f32 v16, s53, v16
    v_mul_f32 v18, s53, v18
    v_exp_f32 v12, v12
    v_exp_f32 v14, v14
    v_exp_f32 v16, v16
    v_exp_f32 v18, v18
    s_nop 0
    v_mul_f32 v21, v12, v13
    v_mul_f32 v2, v12, v2
    v_mul_f32 v3, v12, v3
    v_fmac_f32 v21, v14, v15
    v_fmac_f32 v2, v14, v4
    v_fmac_f32 v3, v14, v5
    v_fmac_f32 v21, v16, v17
    v_fmac_f32 v2, v16, v6
    v_fmac_f32 v3, v16, v7
    v_fmac_f32 v21, v18, v19
    v_fmac_f32 v2, v18, v8
    v_fmac_f32 v3, v18, v9
    s_lshl_b32 s42, s32, 8
    s_lshl_b32 s43, s31, 3
    s_add_u32 s42, s42, s43
    s_add_u32 s42, s42, 8192
    v_mov_b32 v41, s42
    v_add_u32 v40, 13312, v191
    s_cmp_eq_u32 s34, 0
    s_cbranch_scc0 sl_36
    global_store_dwordx2 v40, v[2:3], s[36:37]
    s_branch sld_37
sl_36:
    global_store_dwordx2 v40, v[2:3], s[36:37] sc1
sld_37:
    v_cmp_eq_u32 vcc, 0, v1
    s_and_saveexec_b64 s[50:51], vcc
    s_cmp_eq_u32 s34, 0
    s_cbranch_scc0 sl_38
    global_store_dwordx2 v41, v[20:21], s[36:37]
    s_branch sld_39
sl_38:
    global_store_dwordx2 v41, v[20:21], s[36:37] sc1
sld_39:
    s_mov_b64 exec, s[50:51]
    v_add_u32 v40, 13312, v192
    s_mov_b32 s35, 0x8000
poll_40:
    global_load_dwordx4 v[2:5], v40, s[36:37] sc1
    global_load_dwordx4 v[6:9], v40, s[36:37] offset:1024 sc1
    global_load_dwordx2 v[10:11], v187, s[36:37] sc1
    global_load_dwordx2 v[12:13], v187, s[36:37] offset:128 sc1
pollc_42:
    s_waitcnt vmcnt(0)
    v_max3_u32 v41, v2, v3, v4
    v_max3_u32 v41, v41, v5, v6
    v_max3_u32 v41, v41, v7, v8
    v_max3_u32 v41, v41, v9, v10
    v_max3_u32 v41, v41, v11, v12
    v_max_u32 v41, v41, v13
    v_cmp_eq_u32 vcc, -1, v41
    s_cbranch_vccz polld_41
    s_sub_u32 s35, s35, 1
    s_cbranch_scc0 poll_40
polld_41:
    v_max_f32 v14, v10, v12
    s_nop 1
    v_max_f32_dpp v14, v14, v14 quad_perm:[1,0,3,2] row_mask:0xf bank_mask:0xf
    s_nop 1
    v_max_f32_dpp v14, v14, v14 quad_perm:[2,3,0,1] row_mask:0xf bank_mask:0xf
    s_nop 1
    v_max_f32_dpp v14, v14, v14 row_ror:4 row_mask:0xf bank_mask:0xf
    s_nop 1
    v_max_f32_dpp v14, v14, v14 row_ror:8 row_mask:0xf bank_mask:0xf
    v_sub_f32 v10, v10, v14
    v_sub_f32 v12, v12, v14
    v_mul_f32 v10, s53, v10
    v_mul_f32 v12, s53, v12
    v_exp_f32 v10, v10
    v_exp_f32 v12, v12
    s_nop 0
    v_mul_f32 v15, v10, v11
    v_fmac_f32 v15, v12, v13
    v_mul_f32 v2, v10, v2
    v_fmac_f32 v2, v12, v6
    v_mul_f32 v3, v10, v3
    v_fmac_f32 v3, v12, v7
    v_mul_f32 v4, v10, v4
    v_fmac_f32 v4, v12, v8
    v_mul_f32 v5, v10, v5
    v_fmac_f32 v5, v12, v9
    v_add_f32_dpp v15, v15, v15 quad_perm:[1,0,3,2] row_mask:0xf bank_mask:0xf
    v_add_f32_dpp v2, v2, v2 quad_perm:[1,0,3,2] row_mask:0xf bank_mask:0xf
    v_add_f32_dpp v3, v3, v3 quad_perm:[1,0,3,2] row_mask:0xf bank_mask:0xf
    v_add_f32_dpp v4, v4, v4 quad_perm:[1,0,3,2] row_mask:0xf bank_mask:0xf
    v_add_f32_dpp v5, v5, v5 quad_perm:[1,0,3,2] row_mask:0xf bank_mask:0xf
    v_add_f32_dpp v15, v15, v15 quad_perm:[2,3,0,1] row_mask:0xf bank_mask:0xf
    v_add_f32_dpp v2, v2, v2 quad_perm:[2,3,0,1] row_mask:0xf bank_mask:0xf
    v_add_f32_dpp v3, v3, v3 quad_perm:[2,3,0,1] row_mask:0xf bank_mask:0xf
    v_add_f32_dpp v4, v4, v4 quad_perm:[2,3,0,1] row_mask:0xf bank_mask:0xf
    v_add_f32_dpp v5, v5, v5 quad_perm:[2,3,0,1] row_mask:0xf bank_mask:0xf
    v_add_f32_dpp v15, v15, v15 row_ror:4 row_mask:0xf bank_mask:0xf
    v_add_f32_dpp v2, v2, v2 row_ror:4 row_mask:0xf bank_mask:0xf
    v_add_f32_dpp v3, v3, v3 row_ror:4 row_mask:0xf bank_mask:0xf
    v_add_f32_dpp v4, v4, v4 row_ror:4 row_mask:0xf bank_mask:0xf
    v_add_f32_dpp v5, v5, v5 row_ror:4 row_mask:0xf bank_mask:0xf
    v_add_f32_dpp v15, v15, v15 row_ror:8 row_mask:0xf bank_mask:0xf
    v_add_f32_dpp v2, v2, v2 row_ror:8 row_mask:0xf bank_mask:0xf
    v_add_f32_dpp v3, v3, v3 row_ror:8 row_mask:0xf bank_mask:0xf
    v_add_f32_dpp v4, v4, v4 row_ror:8 row_mask:0xf bank_mask:0xf
    v_add_f32_dpp v5, v5, v5 row_ror:8 row_mask:0xf bank_mask:0xf
    v_rcp_f32 v15, v15
    s_nop 0
    v_mul_f32 v2, v2, v15
    v_mul_f32 v3, v3, v15
    v_mul_f32 v4, v4, v15
    v_mul_f32 v5, v5, v15
    v_cvt_pk_bf16_f32 v16, v2, v3
    v_cvt_pk_bf16_f32 v17, v4, v5
    s_mul_i32 s42, s32, 17408
    s_lshl_b32 s43, s31, 6
    s_add_u32 s42, s42, s43
    s_add_u32 s42, s42, 82944
    v_and_b32 v50, 15, v1
    v_lshlrev_b32 v50, 2, v50
    v_lshrrev_b32 v51, 4, v1
    v_mul_u32_u24 v51, 4352, v51
    v_add3_u32 v50, v50, v51, s42
    v_mfma_f32_16x16x16_bf16 v[200:203], v[16:17], v[144:145], 0
    v_mfma_f32_16x16x16_bf16 v[204:207], v[16:17], v[146:147], 0
    v_mfma_f32_16x16x16_bf16 v[208:211], v[16:17], v[148:149], 0
    v_mfma_f32_16x16x16_bf16 v[212:215], v[16:17], v[150:151], 0
    v_mfma_f32_16x16x16_bf16 v[216:219], v[16:17], v[152:153], 0
    v_mfma_f32_16x16x16_bf16 v[220:223], v[16:17], v[154:155], 0
    v_mfma_f32_16x16x16_bf16 v[224:227], v[16:17], v[156:157], 0
    v_mfma_f32_16x16x16_bf16 v[228:231], v[16:17], v[158:159], 0
    s_nop 7
    v_cndmask_b32 v2, v200, v208, s[80:81]
    v_cndmask_b32 v4, v216, v224, s[80:81]
    v_cndmask_b32 v3, v204, v212, s[80:81]
    v_cndmask_b32 v5, v220, v228, s[80:81]
    v_cndmask_b32 v2, v2, v4, s[82:83]
    v_cndmask_b32 v3, v3, v5, s[82:83]
    s_cmp_eq_u32 s34, 0
    s_cbranch_scc0 sl_43
    global_store_dword v50, v2, s[36:37]
    global_store_dword v50, v3, s[36:37] offset:2176
    s_branch sld_44
sl_43:
    global_store_dword v50, v2, s[36:37] sc1
    global_store_dword v50, v3, s[36:37] offset:2176 sc1
sld_44:
    s_cmp_eq_u32 s32, 0
    s_cbranch_scc0 w0_45
    v_add_u32 v40, 82944, v186
    s_mov_b32 s35, 0x8000
poll_46:
    global_load_dwordx4 v[2:5], v40, s[36:37] sc1
    global_load_dwordx4 v[6:9], v40, s[36:37] offset:1024 sc1
pollc_48:
    s_waitcnt vmcnt(0)
    v_max3_u32 v41, v2, v3, v4
    v_max3_u32 v41, v41, v5, v6
    v_max3_u32 v41, v41, v7, v8
    v_max_u32 v41, v41, v9
    v_cmp_eq_u32 vcc, -1, v41
    s_cbranch_vccz polld_47
    s_sub_u32 s35, s35, 1
    s_cbranch_scc0 poll_46
polld_47:
    v_add_f32 v2, v2, v6
    v_add_f32 v3, v3, v7
    v_add_f32 v4, v4, v8
    v_add_f32 v5, v5, v9
    v_add_f32_dpp v2, v2, v2 row_ror:4 row_mask:0xf bank_mask:0xf
    v_add_f32_dpp v3, v3, v3 row_ror:4 row_mask:0xf bank_mask:0xf
    v_add_f32_dpp v4, v4, v4 row_ror:4 row_mask:0xf bank_mask:0xf
    v_add_f32_dpp v5, v5, v5 row_ror:4 row_mask:0xf bank_mask:0xf
    v_add_f32_dpp v2, v2, v2 row_ror:8 row_mask:0xf bank_mask:0xf
    v_add_f32_dpp v3, v3, v3 row_ror:8 row_mask:0xf bank_mask:0xf
    v_add_f32_dpp v4, v4, v4 row_ror:8 row_mask:0xf bank_mask:0xf
    v_add_f32_dpp v5, v5, v5 row_ror:8 row_mask:0xf bank_mask:0xf
    v_mov_b32 v40, v2
    v_mov_b32 v41, v3
    v_mov_b32 v42, v4
    v_mov_b32 v43, v5
    s_nop 0
    v_permlane16_swap_b32 v40, v2
    v_permlane16_swap_b32 v41, v3
    v_permlane16_swap_b32 v42, v4
    v_permlane16_swap_b32 v43, v5
    s_nop 0
    v_add_f32 v2, v2, v40
    v_add_f32 v3, v3, v41
    v_add_f32 v4, v4, v42
    v_add_f32 v5, v5, v43
    v_mov_b32 v40, v2
    v_mov_b32 v41, v3
    v_mov_b32 v42, v4
    v_mov_b32 v43, v5
    s_nop 0
    v_permlane32_swap_b32 v40, v2
    v_permlane32_swap_b32 v41, v3
    v_permlane32_swap_b32 v42, v4
    v_permlane32_swap_b32 v43, v5
    s_nop 0
    v_add_f32 v2, v2, v40
    v_add_f32 v3, v3, v41
    v_add_f32 v4, v4, v42
    v_add_f32 v5, v5, v43
    s_lshl_b32 s42, s30, 11
    s_lshl_b32 s43, s31, 6
    s_add_u32 s42, s42, s43
    s_add_u32 s42, s42, 0x140000
    v_add_u32 v40, s42, v184
    v_cmp_gt_u32 vcc, 4, v1
    s_and_saveexec_b64 s[50:51], vcc
    global_store_dwordx4 v40, v[2:5], s[40:41] sc1
    s_mov_b64 exec, s[50:51]
    s_mov_b32 s35, 0x8000
poll_49:
    global_load_dwordx2 v[2:3], v188, s[40:41] sc1
pollc_51:
    s_waitcnt vmcnt(0)
    v_max_u32 v40, v2, v3
    v_cmp_eq_u32 vcc, -1, v40
    s_cbranch_vccz polld_50
    s_sub_u32 s35, s35, 1
    s_cbranch_scc0 poll_49
polld_50:
    s_nop 0
    v_add_f32_dpp v2, v2, v2 row_ror:8 row_mask:0xf bank_mask:0xf
    v_add_f32_dpp v3, v3, v3 row_ror:8 row_mask:0xf bank_mask:0xf
    v_mov_b32 v40, v2
    v_mov_b32 v41, v3
    s_nop 0
    v_permlane16_swap_b32 v40, v2
    v_permlane16_swap_b32 v41, v3
    s_nop 0
    v_add_f32 v2, v2, v40
    v_add_f32 v3, v3, v41
    v_mov_b32 v40, v2
    v_mov_b32 v41, v3
    s_nop 0
    v_permlane32_swap_b32 v40, v2
    v_permlane32_swap_b32 v41, v3
    s_nop 0
    v_add_f32 v2, v2, v40
    v_add_f32 v3, v3, v41
    v_cvt_pk_bf16_f32 v40, v2, v3
    v_lshlrev_b32 v2, 16, v40
    v_and_b32 v3, 0xffff0000, v40
    v_add_f32 v182, v182, v2
    v_add_f32 v183, v183, v3
    v_cvt_pk_bf16_f32 v40, v182, v183
    v_lshlrev_b32 v182, 16, v40
    v_and_b32 v183, 0xffff0000, v40
    s_lshl_b32 s42, s31, 6
    s_add_u32 s42, s42, 9216
    v_lshlrev_b32 v40, 3, v1
    v_add_u32 v40, s42, v40
    v_cmp_gt_u32 vcc, 8, v1
    s_and_saveexec_b64 s[50:51], vcc
    s_cmp_eq_u32 s34, 0
    s_cbranch_scc0 sl_52
    global_store_dwordx2 v40, v[182:183], s[36:37]
    s_branch sld_53
sl_52:
    global_store_dwordx2 v40, v[182:183], s[36:37] sc1
sld_53:
    s_mov_b64 exec, s[50:51]
    v_lshlrev_b32 v41, 5, v1
    v_add_u32 v40, 9216, v41
    s_mov_b32 s35, 0x8000
poll_54:
    global_load_dwordx4 v[2:5], v40, s[36:37] sc1
    global_load_dwordx4 v[6:9], v40, s[36:37] offset:16 sc1
pollc_56:
    s_waitcnt vmcnt(0)
    v_max3_u32 v42, v2, v3, v4
    v_max3_u32 v42, v42, v5, v6
    v_max3_u32 v42, v42, v7, v8
    v_max_u32 v42, v42, v9
    v_cmp_eq_u32 vcc, -1, v42
    s_cbranch_vccz polld_55
    s_sub_u32 s35, s35, 1
    s_cbranch_scc0 poll_54
polld_55:
    ds_write_b128 v41, v[2:5] offset:16384
    ds_write_b128 v41, v[6:9] offset:16400
    s_waitcnt lgkmcnt(0)
w0_45:
    s_barrier
    v_lshlrev_b32 v40, 5, v1
    s_lshl_b32 s42, s2, 3
    v_mov_b32 v41, s42
    ds_read_b128 v[2:5], v40 offset:16384
    ds_read_b128 v[6:9], v40 offset:16400
    ds_read_b64 v[10:11], v41 offset:16384
    s_waitcnt lgkmcnt(0)
    v_mov_b32 v12, v10
    v_mov_b32 v13, v11
    v_add_f32 v42, v2, v3
    v_mul_f32 v43, v2, v2
    v_fmac_f32 v43, v3, v3
    v_add_f32 v42, v42, v4
    v_fmac_f32 v43, v4, v4
    v_add_f32 v42, v42, v5
    v_fmac_f32 v43, v5, v5
    v_add_f32 v42, v42, v6
    v_fmac_f32 v43, v6, v6
    v_add_f32 v42, v42, v7
    v_fmac_f32 v43, v7, v7
    v_add_f32 v42, v42, v8
    v_fmac_f32 v43, v8, v8
    v_add_f32 v42, v42, v9
    v_fmac_f32 v43, v9, v9
    s_nop 0
    v_add_f32_dpp v42, v42, v42 quad_perm:[1,0,3,2] row_mask:0xf bank_mask:0xf
    v_add_f32_dpp v43, v43, v43 quad_perm:[1,0,3,2] row_mask:0xf bank_mask:0xf
    s_nop 0
    v_add_f32_dpp v42, v42, v42 quad_perm:[2,3,0,1] row_mask:0xf bank_mask:0xf
    v_add_f32_dpp v43, v43, v43 quad_perm:[2,3,0,1] row_mask:0xf bank_mask:0xf
    s_nop 0
    v_add_f32_dpp v42, v42, v42 row_ror:4 row_mask:0xf bank_mask:0xf
    v_add_f32_dpp v43, v43, v43 row_ror:4 row_mask:0xf bank_mask:0xf
    s_nop 0
    v_add_f32_dpp v42, v42, v42 row_ror:8 row_mask:0xf bank_mask:0xf
    v_add_f32_dpp v43, v43, v43 row_ror:8 row_mask:0xf bank_mask:0xf
    v_mov_b32 v44, v42
    v_mov_b32 v45, v43
    s_nop 0
    v_permlane16_swap_b32 v44, v42
    v_permlane16_swap_b32 v45, v43
    s_nop 0
    v_add_f32 v42, v42, v44
    v_add_f32 v43, v43, v45
    v_mov_b32 v44, v42
    v_mov_b32 v45, v43
    s_nop 0
    v_permlane32_swap_b32 v44, v42
    v_permlane32_swap_b32 v45, v43
    s_nop 0
    v_add_f32 v42, v42, v44
    v_add_f32 v43, v43, v45
    v_mul_f32 v42, 0x3b000000, v42
    v_mul_f32 v43, 0x3b000000, v43
    v_fma_f32 v43, -v42, v42, v43
    v_max_f32 v43, 0, v43
    v_cvt_pk_bf16_f32 v44, v42, v43
    v_lshlrev_b32 v42, 16, v44
    v_and_b32 v43, 0xffff0000, v44
    v_add_f32 v43, 0x3727c5ac, v43
    v_cvt_pk_bf16_f32 v44, v43, v43
    v_lshlrev_b32 v43, 16, v44
    v_sqrt_f32 v43, v43
    s_nop 0
    v_cvt_pk_bf16_f32 v44, v43, v43
    v_lshlrev_b32 v43, 16, v44
    v_rcp_f32 v15, v43
    v_mov_b32 v14, v42
    s_nop 0
    v_pk_add_f32 v[2:3], v[2:3], v[14:15] op_sel:[0,0] op_sel_hi:[1,0] neg_lo:[0,1] neg_hi:[0,1]
    v_cvt_pk_bf16_f32 v42, v2, v3
    v_lshlrev_b32 v2, 16, v42
    v_and_b32 v3, 0xffff0000, v42
    v_pk_mul_f32 v[2:3], v[2:3], v[14:15] op_sel:[0,1] op_sel_hi:[1,1]
    v_cvt_pk_bf16_f32 v42, v2, v3
    v_lshlrev_b32 v2, 16, v42
    v_and_b32 v3, 0xffff0000, v42
    v_pk_add_f32 v[4:5], v[4:5], v[14:15] op_sel:[0,0] op_sel_hi:[1,0] neg_lo:[0,1] neg_hi:[0,1]
    v_cvt_pk_bf16_f32 v42, v4, v5
    v_lshlrev_b32 v4, 16, v42
    v_and_b32 v5, 0xffff0000, v42
    v_pk_mul_f32 v[4:5], v[4:5], v[14:15] op_sel:[0,1] op_sel_hi:[1,1]
    v_cvt_pk_bf16_f32 v42, v4, v5
    v_lshlrev_b32 v4, 16, v42
    v_and_b32 v5, 0xffff0000, v42
    v_pk_add_f32 v[6:7], v[6:7], v[14:15] op_sel:[0,0] op_sel_hi:[1,0] neg_lo:[0,1] neg_hi:[0,1]
    v_cvt_pk_bf16_f32 v42, v6, v7
    v_lshlrev_b32 v6, 16, v42
    v_and_b32 v7, 0xffff0000, v42
    v_pk_mul_f32 v[6:7], v[6:7], v[14:15] op_sel:[0,1] op_sel_hi:[1,1]
    v_cvt_pk_bf16_f32 v42, v6, v7
    v_lshlrev_b32 v6, 16, v42
    v_and_b32 v7, 0xffff0000, v42
    v_pk_add_f32 v[8:9], v[8:9], v[14:15] op_sel:[0,0] op_sel_hi:[1,0] neg_lo:[0,1] neg_hi:[0,1]
    v_cvt_pk_bf16_f32 v42, v8, v9
    v_lshlrev_b32 v8, 16, v42
    v_and_b32 v9, 0xffff0000, v42
    v_pk_mul_f32 v[8:9], v[8:9], v[14:15] op_sel:[0,1] op_sel_hi:[1,1]
    v_cvt_pk_bf16_f32 v42, v8, v9
    v_lshlrev_b32 v8, 16, v42
    v_and_b32 v9, 0xffff0000, v42
    v_pk_add_f32 v[10:11], v[10:11], v[14:15] op_sel:[0,0] op_sel_hi:[1,0] neg_lo:[0,1] neg_hi:[0,1]
    v_cvt_pk_bf16_f32 v42, v10, v11
    v_lshlrev_b32 v10, 16, v42
    v_and_b32 v11, 0xffff0000, v42
    v_pk_mul_f32 v[10:11], v[10:11], v[14:15] op_sel:[0,1] op_sel_hi:[1,1]
    v_cvt_pk_bf16_f32 v42, v10, v11
    v_lshlrev_b32 v10, 16, v42
    v_and_b32 v11, 0xffff0000, v42
    v_add_f32 v42, v2, v3
    v_mul_f32 v43, v2, v2
    v_fmac_f32 v43, v3, v3
    v_add_f32 v42, v42, v4
    v_fmac_f32 v43, v4, v4
    v_add_f32 v42, v42, v5
    v_fmac_f32 v43, v5, v5
    v_add_f32 v42, v42, v6
    v_fmac_f32 v43, v6, v6
    v_add_f32 v42, v42, v7
    v_fmac_f32 v43, v7, v7
    v_add_f32 v42, v42, v8
    v_fmac_f32 v43, v8, v8
    v_add_f32 v42, v42, v9
    v_fmac_f32 v43, v9, v9
    s_nop 0
    v_add_f32_dpp v42, v42, v42 quad_perm:[1,0,3,2] row_mask:0xf bank_mask:0xf
    v_add_f32_dpp v43, v43, v43 quad_perm:[1,0,3,2] row_mask:0xf bank_mask:0xf
    s_nop 0
    v_add_f32_dpp v42, v42, v42 quad_perm:[2,3,0,1] row_mask:0xf bank_mask:0xf
    v_add_f32_dpp v43, v43, v43 quad_perm:[2,3,0,1] row_mask:0xf bank_mask:0xf
    s_nop 0
    v_add_f32_dpp v42, v42, v42 row_ror:4 row_mask:0xf bank_mask:0xf
    v_add_f32_dpp v43, v43, v43 row_ror:4 row_mask:0xf bank_mask:0xf
    s_nop 0
    v_add_f32_dpp v42, v42, v42 row_ror:8 row_mask:0xf bank_mask:0xf
    v_add_f32_dpp v43, v43, v43 row_ror:8 row_mask:0xf bank_mask:0xf
    v_mov_b32 v44, v42
    v_mov_b32 v45, v43
    s_nop 0
    v_permlane16_swap_b32 v44, v42
    v_permlane16_swap_b32 v45, v43
    s_nop 0
    v_add_f32 v42, v42, v44
    v_add_f32 v43, v43, v45
    v_mov_b32 v44, v42
    v_mov_b32 v45, v43
    s_nop 0
    v_permlane32_swap_b32 v44, v42
    v_permlane32_swap_b32 v45, v43
    s_nop 0
    v_add_f32 v42, v42, v44
    v_add_f32 v43, v43, v45
    v_mul_f32 v42, 0x3b000000, v42
    v_mul_f32 v43, 0x3b000000, v43
    v_fma_f32 v43, -v42, v42, v43
    v_max_f32 v43, 0, v43
    v_cvt_pk_bf16_f32 v44, v42, v43
    v_lshlrev_b32 v42, 16, v44
    v_and_b32 v43, 0xffff0000, v44
    v_add_f32 v43, 0x3727c5ac, v43
    v_cvt_pk_bf16_f32 v44, v43, v43
    v_lshlrev_b32 v43, 16, v44
    v_sqrt_f32 v43, v43
    s_nop 0
    v_cvt_pk_bf16_f32 v44, v43, v43
    v_lshlrev_b32 v43, 16, v44
    v_rcp_f32 v15, v43
    v_mov_b32 v14, v42
    s_nop 0
    v_pk_add_f32 v[10:11], v[10:11], v[14:15] op_sel:[0,0] op_sel_hi:[1,0] neg_lo:[0,1] neg_hi:[0,1]
    v_cvt_pk_bf16_f32 v42, v10, v11
    v_lshlrev_b32 v10, 16, v42
    v_and_b32 v11, 0xffff0000, v42
    v_pk_mul_f32 v[10:11], v[10:11], v[14:15] op_sel:[0,1] op_sel_hi:[1,1]
    v_cvt_pk_bf16_f32 v42, v10, v11
    v_lshlrev_b32 v10, 16, v42
    v_and_b32 v11, 0xffff0000, v42
    s_mov_b32 s54, 0xc0135761
    s_mov_b32 s55, 0xbdd2d3e8
    v_mov_b32 v16, 0
    v_mov_b32 v17, 0
    v_mov_b32 v30, s54
    v_mov_b32 v31, s55
    v_mov_b32 v32, 1.0
    v_pk_mul_f32 v[200:201], v[10:11], v[160:161] op_sel:[0,0] op_sel_hi:[1,0]
    v_pk_mul_f32 v[202:203], v[10:11], v[160:161] op_sel:[0,1] op_sel_hi:[1,1]
    v_pk_mul_f32 v[204:205], v[10:11], v[162:163] op_sel:[0,0] op_sel_hi:[1,0]
    v_pk_mul_f32 v[206:207], v[10:11], v[162:163] op_sel:[0,1] op_sel_hi:[1,1]
    v_pk_mul_f32 v[208:209], v[10:11], v[164:165] op_sel:[0,0] op_sel_hi:[1,0]
    v_pk_mul_f32 v[210:211], v[10:11], v[164:165] op_sel:[0,1] op_sel_hi:[1,1]
    v_pk_mul_f32 v[212:213], v[10:11], v[166:167] op_sel:[0,0] op_sel_hi:[1,0]
    v_cvt_pk_bf16_f32 v24, v200, v201
    v_lshlrev_b32 v200, 16, v24
    v_and_b32 v201, 0xffff0000, v24
    v_cvt_pk_bf16_f32 v24, v202, v203
    v_lshlrev_b32 v202, 16, v24
    v_and_b32 v203, 0xffff0000, v24
    v_cvt_pk_bf16_f32 v24, v204, v205
    v_lshlrev_b32 v204, 16, v24
    v_and_b32 v205, 0xffff0000, v24
    v_cvt_pk_bf16_f32 v24, v206, v207
    v_lshlrev_b32 v206, 16, v24
    v_and_b32 v207, 0xffff0000, v24
    v_cvt_pk_bf16_f32 v24, v208, v209
    v_lshlrev_b32 v208, 16, v24
    v_and_b32 v209, 0xffff0000, v24
    v_cvt_pk_bf16_f32 v24, v210, v211
    v_lshlrev_b32 v210, 16, v24
    v_and_b32 v211, 0xffff0000, v24
    v_cvt_pk_bf16_f32 v24, v212, v213
    v_lshlrev_b32 v212, 16, v24
    v_and_b32 v213, 0xffff0000, v24
    v_pk_add_f32 v[200:201], v[200:201], v[166:167] op_sel:[0,1] op_sel_hi:[1,1]
    v_pk_add_f32 v[202:203], v[202:203], v[168:169] op_sel:[0,0] op_sel_hi:[1,0]
    v_pk_add_f32 v[204:205], v[204:205], v[168:169] op_sel:[0,1] op_sel_hi:[1,1]
    v_pk_add_f32 v[206:207], v[206:207], v[170:171] op_sel:[0,0] op_sel_hi:[1,0]
    v_pk_add_f32 v[208:209], v[208:209], v[170:171] op_sel:[0,1] op_sel_hi:[1,1]
    v_pk_add_f32 v[210:211], v[210:211], v[172:173] op_sel:[0,0] op_sel_hi:[1,0]
    v_pk_add_f32 v[212:213], v[212:213], v[172:173] op_sel:[0,1] op_sel_hi:[1,1]
    v_cvt_pk_bf16_f32 v24, v200, v201
    v_lshlrev_b32 v200, 16, v24
    v_and_b32 v201, 0xffff0000, v24
    v_cvt_pk_bf16_f32 v24, v202, v203
    v_lshlrev_b32 v202, 16, v24
    v_and_b32 v203, 0xffff0000, v24
    v_cvt_pk_bf16_f32 v24, v204, v205
    v_lshlrev_b32 v204, 16, v24
    v_and_b32 v205, 0xffff0000, v24
    v_cvt_pk_bf16_f32 v24, v206, v207
    v_lshlrev_b32 v206, 16, v24
    v_and_b32 v207, 0xffff0000, v24
    v_cvt_pk_bf16_f32 v24, v208, v209
    v_lshlrev_b32 v208, 16, v24
    v_and_b32 v209, 0xffff0000, v24
    v_cvt_pk_bf16_f32 v24, v210, v211
    v_lshlrev_b32 v210, 16, v24
    v_and_b32 v211, 0xffff0000, v24
    v_cvt_pk_bf16_f32 v24, v212, v213
    v_lshlrev_b32 v212, 16, v24
    v_and_b32 v213, 0xffff0000, v24
    v_pk_mul_f32 v[216:217], v[200:201], v[200:201]
    v_pk_mul_f32 v[218:219], v[202:203], v[202:203]
    v_pk_mul_f32 v[220:221], v[204:205], v[204:205]
    v_pk_mul_f32 v[222:223], v[206:207], v[206:207]
    v_pk_mul_f32 v[224:225], v[208:209], v[208:209]
    v_pk_mul_f32 v[226:227], v[210:211], v[210:211]
    v_pk_mul_f32 v[228:229], v[212:213], v[212:213]
    v_pk_fma_f32 v[216:217], v[216:217], v[30:31], v[30:31] op_sel:[0,1,0] op_sel_hi:[1,1,0]
    v_pk_fma_f32 v[218:219], v[218:219], v[30:31], v[30:31] op_sel:[0,1,0] op_sel_hi:[1,1,0]
    v_pk_fma_f32 v[220:221], v[220:221], v[30:31], v[30:31] op_sel:[0,1,0] op_sel_hi:[1,1,0]
    v_pk_fma_f32 v[222:223], v[222:223], v[30:31], v[30:31] op_sel:[0,1,0] op_sel_hi:[1,1,0]
    v_pk_fma_f32 v[224:225], v[224:225], v[30:31], v[30:31] op_sel:[0,1,0] op_sel_hi:[1,1,0]
    v_pk_fma_f32 v[226:227], v[226:227], v[30:31], v[30:31] op_sel:[0,1,0] op_sel_hi:[1,1,0]
    v_pk_fma_f32 v[228:229], v[228:229], v[30:31], v[30:31] op_sel:[0,1,0] op_sel_hi:[1,1,0]
    v_pk_mul_f32 v[216:217], v[216:217], v[200:201]
    v_pk_mul_f32 v[218:219], v[218:219], v[202:203]
    v_pk_mul_f32 v[220:221], v[220:221], v[204:205]
    v_pk_mul_f32 v[222:223], v[222:223], v[206:207]
    v_pk_mul_f32 v[224:225], v[224:225], v[208:209]
    v_pk_mul_f32 v[226:227], v[226:227], v[210:211]
    v_pk_mul_f32 v[228:229], v[228:229], v[212:213]
    v_exp_f32 v216, v216
    v_exp_f32 v217, v217
    v_exp_f32 v218, v218
    v_exp_f32 v219, v219
    v_exp_f32 v220, v220
    v_exp_f32 v221, v221
    v_exp_f32 v222, v222
    v_exp_f32 v223, v223
    v_exp_f32 v224, v224
    v_exp_f32 v225, v225
    v_exp_f32 v226, v226
    v_exp_f32 v227, v227
    v_exp_f32 v228, v228
    v_exp_f32 v229, v229
    v_pk_add_f32 v[216:217], v[216:217], v[32:33] op_sel:[0,0] op_sel_hi:[1,0]
    v_pk_add_f32 v[218:219], v[218:219], v[32:33] op_sel:[0,0] op_sel_hi:[1,0]
    v_pk_add_f32 v[220:221], v[220:221], v[32:33] op_sel:[0,0] op_sel_hi:[1,0]
    v_pk_add_f32 v[222:223], v[222:223], v[32:33] op_sel:[0,0] op_sel_hi:[1,0]
    v_pk_add_f32 v[224:225], v[224:225], v[32:33] op_sel:[0,0] op_sel_hi:[1,0]
    v_pk_add_f32 v[226:227], v[226:227], v[32:33] op_sel:[0,0] op_sel_hi:[1,0]
    v_pk_add_f32 v[228:229], v[228:229], v[32:33] op_sel:[0,0] op_sel_hi:[1,0]
    v_rcp_f32 v216, v216
    v_rcp_f32 v217, v217
    v_rcp_f32 v218, v218
    v_rcp_f32 v219, v219
    v_rcp_f32 v220, v220
    v_rcp_f32 v221, v221
    v_rcp_f32 v222, v222
    v_rcp_f32 v223, v223
    v_rcp_f32 v224, v224
    v_rcp_f32 v225, v225
    v_rcp_f32 v226, v226
    v_rcp_f32 v227, v227
    v_rcp_f32 v228, v228
    v_rcp_f32 v229, v229
    v_pk_mul_f32 v[200:201], v[200:201], v[216:217]
    v_pk_mul_f32 v[202:203], v[202:203], v[218:219]
    v_pk_mul_f32 v[204:205], v[204:205], v[220:221]
    v_pk_mul_f32 v[206:207], v[206:207], v[222:223]
    v_pk_mul_f32 v[208:209], v[208:209], v[224:225]
    v_pk_mul_f32 v[210:211], v[210:211], v[226:227]
    v_pk_mul_f32 v[212:213], v[212:213], v[228:229]
    v_cvt_pk_bf16_f32 v24, v200, v201
    v_lshlrev_b32 v200, 16, v24
    v_and_b32 v201, 0xffff0000, v24
    v_cvt_pk_bf16_f32 v24, v202, v203
    v_lshlrev_b32 v202, 16, v24
    v_and_b32 v203, 0xffff0000, v24
    v_cvt_pk_bf16_f32 v24, v204, v205
    v_lshlrev_b32 v204, 16, v24
    v_and_b32 v205, 0xffff0000, v24
    v_cvt_pk_bf16_f32 v24, v206, v207
    v_lshlrev_b32 v206, 16, v24
    v_and_b32 v207, 0xffff0000, v24
    v_cvt_pk_bf16_f32 v24, v208, v209
    v_lshlrev_b32 v208, 16, v24
    v_and_b32 v209, 0xffff0000, v24
    v_cvt_pk_bf16_f32 v24, v210, v211
    v_lshlrev_b32 v210, 16, v24
    v_and_b32 v211, 0xffff0000, v24
    v_cvt_pk_bf16_f32 v24, v212, v213
    v_lshlrev_b32 v212, 16, v24
    v_and_b32 v213, 0xffff0000, v24
    v_pk_fma_f32 v[16:17], v[200:201], v[174:175], v[16:17] op_sel:[0,0,0] op_sel_hi:[1,0,1]
    v_pk_fma_f32 v[16:17], v[202:203], v[174:175], v[16:17] op_sel:[0,1,0] op_sel_hi:[1,1,1]
    v_pk_fma_f32 v[16:17], v[204:205], v[176:177], v[16:17] op_sel:[0,0,0] op_sel_hi:[1,0,1]
    v_pk_fma_f32 v[16:17], v[206:207], v[176:177], v[16:17] op_sel:[0,1,0] op_sel_hi:[1,1,1]
    v_pk_fma_f32 v[16:17], v[208:209], v[178:179], v[16:17] op_sel:[0,0,0] op_sel_hi:[1,0,1]
    v_pk_fma_f32 v[16:17], v[210:211], v[178:179], v[16:17] op_sel:[0,1,0] op_sel_hi:[1,1,1]
    v_pk_fma_f32 v[16:17], v[212:213], v[180:181], v[16:17] op_sel:[0,0,0] op_sel_hi:[1,0,1]
    s_nop 0
    v_add_f32_dpp v16, v16, v16 quad_perm:[1,0,3,2] row_mask:0xf bank_mask:0xf
    v_add_f32_dpp v17, v17, v17 quad_perm:[1,0,3,2] row_mask:0xf bank_mask:0xf
    s_nop 0
    v_add_f32_dpp v16, v16, v16 quad_perm:[2,3,0,1] row_mask:0xf bank_mask:0xf
    v_add_f32_dpp v17, v17, v17 quad_perm:[2,3,0,1] row_mask:0xf bank_mask:0xf
    s_nop 0
    v_add_f32_dpp v16, v16, v16 row_ror:4 row_mask:0xf bank_mask:0xf
    v_add_f32_dpp v17, v17, v17 row_ror:4 row_mask:0xf bank_mask:0xf
    s_nop 0
    v_add_f32_dpp v16, v16, v16 row_ror:8 row_mask:0xf bank_mask:0xf
    v_add_f32_dpp v17, v17, v17 row_ror:8 row_mask:0xf bank_mask:0xf
    v_mov_b32 v40, v16
    v_mov_b32 v41, v17
    s_nop 0
    v_permlane16_swap_b32 v40, v16
    v_permlane16_swap_b32 v41, v17
    s_nop 0
    v_add_f32 v16, v16, v40
    v_add_f32 v17, v17, v41
    v_mov_b32 v40, v16
    v_mov_b32 v41, v17
    s_nop 0
    v_permlane32_swap_b32 v40, v16
    v_permlane32_swap_b32 v41, v17
    s_nop 0
    v_add_f32 v16, v16, v40
    v_add_f32 v17, v17, v41
    s_lshl_b32 s42, s32, 3
    v_mov_b32 v40, s42
    ds_write_b64 v40, v[16:17] offset:33920
    s_waitcnt lgkmcnt(0)
    s_barrier
    s_cmp_eq_u32 s32, 0
    s_cbranch_scc0 L_end
    v_mov_b32 v40, 0
    ds_read_b128 v[2:5], v40 offset:33920
    ds_read_b128 v[6:9], v40 offset:33936
    s_waitcnt lgkmcnt(0)
    v_add_f32 v2, v2, v4
    v_add_f32 v3, v3, v5
    v_add_f32 v2, v2, v6
    v_add_f32 v3, v3, v7
    v_add_f32 v2, v2, v8
    v_add_f32 v3, v3, v9
    v_cvt_pk_bf16_f32 v40, v2, v3
    v_lshlrev_b32 v2, 16, v40
    v_and_b32 v3, 0xffff0000, v40
    v_add_f32 v2, v2, v181
    v_add_f32 v3, v3, v181
    v_cvt_pk_bf16_f32 v40, v2, v3
    v_lshlrev_b32 v2, 16, v40
    v_and_b32 v3, 0xffff0000, v40
    v_add_f32 v2, v12, v2
    v_add_f32 v3, v13, v3
    v_cvt_pk_bf16_f32 v4, v2, v3
    s_lshl_b32 s42, s2, 2
    v_mov_b32 v40, s42
    v_cmp_eq_u32 vcc, 0, v1
    s_and_saveexec_b64 s[50:51], vcc
    global_store_dword v40, v4, s[24:25]
    s_cmp_eq_u32 s2, 0
    s_cbranch_scc0 L_noep
    v_mov_b32 v40, 32768
    v_mov_b32 v42, s66
    v_mov_b32 v43, s67
    global_store_dwordx2 v40, v[42:43], s[28:29] sc1
L_noep:
    s_waitcnt vmcnt(0)
    s_branch L_end
L_helper:
    s_setprio 3
    v_lshlrev_b32 v2, 4, v1
    global_load_dwordx4 v[24:27], v2, s[4:5]
    s_lshr_b32 s42, s31, 3
    s_lshl_b32 s43, s42, 8
    v_lshlrev_b32 v8, 2, v1
    v_add_u32 v9, s43, v8
    global_load_dword v28, v9, s[4:5]
    s_lshl_b32 s43, s42, 20
    s_lshl_b32 s44, s30, 10
    s_add_u32 s43, s43, s44
    s_and_b32 s44, s31, 7
    s_lshl_b32 s44, s44, 7
    s_add_u32 s43, s43, s44
    v_lshrrev_b32 v3, 3, v1
    v_lshlrev_b32 v9, 13, v3
    v_and_b32 v10, 7, v1
    v_lshlrev_b32 v11, 4, v10
    v_add3_u32 v9, v9, v11, s43
    global_load_dwordx4 v[64:67], v9, s[10:11] nt
    v_add_u32 v9, 0x10000, v9
    global_load_dwordx4 v[68:71], v9, s[10:11] nt
    v_add_u32 v9, 0x10000, v9
    global_load_dwordx4 v[72:75], v9, s[10:11] nt
    v_add_u32 v9, 0x10000, v9
    global_load_dwordx4 v[76:79], v9, s[10:11] nt
    v_add_u32 v9, 0x10000, v9
    global_load_dwordx4 v[80:83], v9, s[10:11] nt
    v_add_u32 v9, 0x10000, v9
    global_load_dwordx4 v[84:87], v9, s[10:11] nt
    v_add_u32 v9, 0x10000, v9
    global_load_dwordx4 v[88:91], v9, s[10:11] nt
    v_add_u32 v9, 0x10000, v9
    global_load_dwordx4 v[92:95], v9, s[10:11] nt
    v_add_u32 v9, 0x10000, v9
    global_load_dwordx4 v[96:99], v9, s[10:11] nt
    v_add_u32 v9, 0x10000, v9
    global_load_dwordx4 v[100:103], v9, s[10:11] nt
    v_add_u32 v9, 0x10000, v9
    global_load_dwordx4 v[104:107], v9, s[10:11] nt
    v_add_u32 v9, 0x10000, v9
    global_load_dwordx4 v[108:111], v9, s[10:11] nt
    v_add_u32 v9, 0x10000, v9
    global_load_dwordx4 v[112:115], v9, s[10:11] nt
    v_add_u32 v9, 0x10000, v9
    global_load_dwordx4 v[116:119], v9, s[10:11] nt
    v_add_u32 v9, 0x10000, v9
    global_load_dwordx4 v[120:123], v9, s[10:11] nt
    v_add_u32 v9, 0x10000, v9
    global_load_dwordx4 v[124:127], v9, s[10:11] nt
    s_barrier
    s_waitcnt vmcnt(16)
    v_lshlrev_b32 v40, 16, v24
    v_and_b32 v41, 0xffff0000, v24
    v_lshlrev_b32 v42, 16, v25
    v_and_b32 v43, 0xffff0000, v25
    v_lshlrev_b32 v44, 16, v26
    v_and_b32 v45, 0xffff0000, v26
    v_lshlrev_b32 v46, 16, v27
    v_and_b32 v47, 0xffff0000, v27
    v_lshlrev_b32 v30, 16, v28
    v_and_b32 v31, 0xffff0000, v28
    v_add_f32 v50, v40, v41
    v_mul_f32 v51, v40, v40
    v_fmac_f32 v51, v41, v41
    v_add_f32 v50, v50, v42
    v_fmac_f32 v51, v42, v42
    v_add_f32 v50, v50, v43
    v_fmac_f32 v51, v43, v43
    v_add_f32 v50, v50, v44
    v_fmac_f32 v51, v44, v44
    v_add_f32 v50, v50, v45
    v_fmac_f32 v51, v45, v45
    v_add_f32 v50, v50, v46
    v_fmac_f32 v51, v46, v46
    v_add_f32 v50, v50, v47
    v_fmac_f32 v51, v47, v47
    s_nop 0
    v_add_f32_dpp v50, v50, v50 quad_perm:[1,0,3,2] row_mask:0xf bank_mask:0xf
    v_add_f32_dpp v51, v51, v51 quad_perm:[1,0,3,2] row_mask:0xf bank_mask:0xf
    s_nop 0
    v_add_f32_dpp v50, v50, v50 quad_perm:[2,3,0,1] row_mask:0xf bank_mask:0xf
    v_add_f32_dpp v51, v51, v51 quad_perm:[2,3,0,1] row_mask:0xf bank_mask:0xf
    s_nop 0
    v_add_f32_dpp v50, v50, v50 row_ror:4 row_mask:0xf bank_mask:0xf
    v_add_f32_dpp v51, v51, v51 row_ror:4 row_mask:0xf bank_mask:0xf
    s_nop 0
    v_add_f32_dpp v50, v50, v50 row_ror:8 row_mask:0xf bank_mask:0xf
    v_add_f32_dpp v51, v51, v51 row_ror:8 row_mask:0xf bank_mask:0xf
    v_mov_b32 v52, v50
    v_mov_b32 v53, v51
    s_nop 0
    v_permlane16_swap_b32 v52, v50
    v_permlane16_swap_b32 v53, v51
    s_nop 0
    v_add_f32 v50, v50, v52
    v_add_f32 v51, v51, v53
    v_mov_b32 v52, v50
    v_mov_b32 v53, v51
    s_nop 0
    v_permlane32_swap_b32 v52, v50
    v_permlane32_swap_b32 v53, v51
    s_nop 0
    v_add_f32 v50, v50, v52
    v_add_f32 v51, v51, v53
    v_mul_f32 v50, 0x3b000000, v50
    v_mul_f32 v51, 0x3b000000, v51
    v_fma_f32 v51, -v50, v50, v51
    v_max_f32 v51, 0, v51
    v_cvt_pk_bf16_f32 v52, v50, v51
    v_lshlrev_b32 v50, 16, v52
    v_and_b32 v51, 0xffff0000, v52
    v_add_f32 v51, 0x3727c5ac, v51
    v_cvt_pk_bf16_f32 v52, v51, v51
    v_lshlrev_b32 v51, 16, v52
    v_sqrt_f32 v51, v51
    s_nop 0
    v_cvt_pk_bf16_f32 v52, v51, v51
    v_lshlrev_b32 v51, 16, v52
    v_rcp_f32 v49, v51
    v_mov_b32 v48, v50
    s_nop 0
    v_pk_add_f32 v[30:31], v[30:31], v[48:49] op_sel:[0,0] op_sel_hi:[1,0] neg_lo:[0,1] neg_hi:[0,1]
    v_cvt_pk_bf16_f32 v50, v30, v31
    v_lshlrev_b32 v30, 16, v50
    v_and_b32 v31, 0xffff0000, v50
    v_pk_mul_f32 v[30:31], v[30:31], v[48:49] op_sel:[0,1] op_sel_hi:[1,1]
    v_cvt_pk_bf16_f32 v50, v30, v31
    v_lshlrev_b32 v30, 16, v50
    v_and_b32 v31, 0xffff0000, v50
    v_cvt_pk_bf16_f32 v32, v30, v31
    ds_write_b32 v8, v32 offset:34048
    s_waitcnt lgkmcnt(0)
    s_add_u32 s66, s66, 1
    s_addc_u32 s67, s67, 0
    v_lshrrev_b32 v12, 4, v1
    v_lshlrev_b32 v13, 4, v12
    ds_read_b128 v[130:133], v13 offset:34048
    ds_read_b128 v[134:137], v13 offset:34112
    ds_read_b128 v[138:141], v13 offset:34176
    ds_read_b128 v[142:145], v13 offset:34240
    s_waitcnt vmcnt(15)
    ds_write_b128 v2, v[64:67] offset:36864
    s_waitcnt vmcnt(14)
    ds_write_b128 v2, v[68:71] offset:37888
    s_waitcnt vmcnt(13)
    ds_write_b128 v2, v[72:75] offset:38912
    s_waitcnt vmcnt(12)
    ds_write_b128 v2, v[76:79] offset:39936
    s_waitcnt vmcnt(11)
    ds_write_b128 v2, v[80:83] offset:40960
    s_waitcnt vmcnt(10)
    ds_write_b128 v2, v[84:87] offset:41984
    s_waitcnt vmcnt(9)
    ds_write_b128 v2, v[88:91] offset:43008
    s_waitcnt vmcnt(8)
    ds_write_b128 v2, v[92:95] offset:44032
    s_waitcnt vmcnt(7)
    ds_write_b128 v2, v[96:99] offset:45056
    s_waitcnt vmcnt(6)
    ds_write_b128 v2, v[100:103] offset:46080
    s_waitcnt vmcnt(5)
    ds_write_b128 v2, v[104:107] offset:47104
    s_waitcnt vmcnt(4)
    ds_write_b128 v2, v[108:111] offset:48128
    s_waitcnt vmcnt(3)
    ds_write_b128 v2, v[112:115] offset:49152
    s_waitcnt vmcnt(2)
    ds_write_b128 v2, v[116:119] offset:50176
    s_waitcnt vmcnt(1)
    ds_write_b128 v2, v[120:123] offset:51200
    s_waitcnt vmcnt(0)
    ds_write_b128 v2, v[124:127] offset:52224
    v_and_b32 v14, 15, v1
    v_lshrrev_b32 v15, 2, v14
    v_lshl_add_u32 v15, v12, 3, v15
    v_lshlrev_b32 v15, 7, v15
    v_and_b32 v14, 3, v14
    v_lshl_add_u32 v15, v14, 3, v15
    s_waitcnt lgkmcnt(0)
    ds_read_b64_tr_b16 v[64:65], v15 offset:36864
    ds_read_b64_tr_b16 v[66:67], v15 offset:37376
    ds_read_b64_tr_b16 v[68:69], v15 offset:40960
    ds_read_b64_tr_b16 v[70:71], v15 offset:41472
    ds_read_b64_tr_b16 v[72:73], v15 offset:45056
    ds_read_b64_tr_b16 v[74:75], v15 offset:45568
    ds_read_b64_tr_b16 v[76:77], v15 offset:49152
    ds_read_b64_tr_b16 v[78:79], v15 offset:49664
    ds_read_b64_tr_b16 v[80:81], v15 offset:36896
    ds_read_b64_tr_b16 v[82:83], v15 offset:37408
    ds_read_b64_tr_b16 v[84:85], v15 offset:40992
    ds_read_b64_tr_b16 v[86:87], v15 offset:41504
    ds_read_b64_tr_b16 v[88:89], v15 offset:45088
    ds_read_b64_tr_b16 v[90:91], v15 offset:45600
    ds_read_b64_tr_b16 v[92:93], v15 offset:49184
    ds_read_b64_tr_b16 v[94:95], v15 offset:49696
    s_waitcnt lgkmcnt(8)
    v_mfma_f32_16x16x32_bf16 v[146:149], v[130:133], v[64:67], 0
    v_mfma_f32_16x16x32_bf16 v[146:149], v[134:137], v[68:71], v[146:149]
    v_mfma_f32_16x16x32_bf16 v[146:149], v[138:141], v[72:75], v[146:149]
    v_mfma_f32_16x16x32_bf16 v[146:149], v[142:145], v[76:79], v[146:149]
    ds_read_b64_tr_b16 v[96:97], v15 offset:36928
    ds_read_b64_tr_b16 v[98:99], v15 offset:37440
    ds_read_b64_tr_b16 v[100:101], v15 offset:41024
    ds_read_b64_tr_b16 v[102:103], v15 offset:41536
    ds_read_b64_tr_b16 v[104:105], v15 offset:45120
    ds_read_b64_tr_b16 v[106:107], v15 offset:45632
    ds_read_b64_tr_b16 v[108:109], v15 offset:49216
    ds_read_b64_tr_b16 v[110:111], v15 offset:49728
    s_waitcnt lgkmcnt(8)
    v_mfma_f32_16x16x32_bf16 v[150:153], v[130:133], v[80:83], 0
    v_mfma_f32_16x16x32_bf16 v[150:153], v[134:137], v[84:87], v[150:153]
    v_mfma_f32_16x16x32_bf16 v[150:153], v[138:141], v[88:91], v[150:153]
    v_mfma_f32_16x16x32_bf16 v[150:153], v[142:145], v[92:95], v[150:153]
    ds_read_b64_tr_b16 v[112:113], v15 offset:36960
    ds_read_b64_tr_b16 v[114:115], v15 offset:37472
    ds_read_b64_tr_b16 v[116:117], v15 offset:41056
    ds_read_b64_tr_b16 v[118:119], v15 offset:41568
    ds_read_b64_tr_b16 v[120:121], v15 offset:45152
    ds_read_b64_tr_b16 v[122:123], v15 offset:45664
    ds_read_b64_tr_b16 v[124:125], v15 offset:49248
    ds_read_b64_tr_b16 v[126:127], v15 offset:49760
    s_waitcnt lgkmcnt(8)
    v_mfma_f32_16x16x32_bf16 v[154:157], v[130:133], v[96:99], 0
    v_mfma_f32_16x16x32_bf16 v[154:157], v[134:137], v[100:103], v[154:157]
    v_mfma_f32_16x16x32_bf16 v[154:157], v[138:141], v[104:107], v[154:157]
    v_mfma_f32_16x16x32_bf16 v[154:157], v[142:145], v[108:111], v[154:157]
    s_waitcnt lgkmcnt(0)
    v_mfma_f32_16x16x32_bf16 v[158:161], v[130:133], v[112:115], 0
    v_mfma_f32_16x16x32_bf16 v[158:161], v[134:137], v[116:119], v[158:161]
    v_mfma_f32_16x16x32_bf16 v[158:161], v[138:141], v[120:123], v[158:161]
    v_mfma_f32_16x16x32_bf16 v[158:161], v[142:145], v[124:127], v[158:161]
    s_lshl_b32 s42, s30, 14
    s_lshr_b32 s43, s31, 3
    s_lshl_b32 s43, s43, 12
    s_add_u32 s42, s42, s43
    s_and_b32 s43, s31, 7
    s_lshl_b32 s43, s43, 9
    s_add_u32 s42, s42, s43
    s_add_u32 s42, s42, 65536
    v_lshlrev_b32 v17, 3, v1
    v_add_u32 v17, s42, v17
    v_and_b32 v18, 0x31, v1
    s_nop 5
    v_mov_b32_dpp v147, v146 quad_perm:[1,1,3,3] row_mask:0xf bank_mask:0xf
    v_mov_b32 v148, s66
    v_mov_b32 v149, s67
    v_mov_b32_dpp v151, v150 quad_perm:[1,1,3,3] row_mask:0xf bank_mask:0xf
    v_mov_b32 v152, s66
    v_mov_b32 v153, s67
    v_mov_b32_dpp v155, v154 quad_perm:[1,1,3,3] row_mask:0xf bank_mask:0xf
    v_mov_b32 v156, s66
    v_mov_b32 v157, s67
    v_mov_b32_dpp v159, v158 quad_perm:[1,1,3,3] row_mask:0xf bank_mask:0xf
    v_mov_b32 v160, s66
    v_mov_b32 v161, s67
    v_cmp_eq_u32 vcc, 0, v18
    s_and_saveexec_b64 s[50:51], vcc
    global_store_dwordx4 v17, v[146:149], s[28:29] offset:0 sc1
    global_store_dwordx4 v17, v[150:153], s[28:29] offset:128 sc1
    global_store_dwordx4 v17, v[154:157], s[28:29] offset:256 sc1
    global_store_dwordx4 v17, v[158:161], s[28:29] offset:384 sc1
    s_mov_b64 exec, s[50:51]
    s_setprio 0
    v_mov_b32 v4, -1
    v_mov_b32 v5, -1
    v_mov_b32 v6, -1
    v_mov_b32 v7, -1
    s_add_u32 s40, s28, 196608
    s_addc_u32 s41, s29, 0
    s_mul_i32 s42, s30, 163840
    s_add_u32 s36, s40, s42
    s_addc_u32 s37, s41, 0
    s_mul_i32 s42, s31, 5120
    v_add_u32 v36, s42, v2
    global_store_dwordx4 v36, v[4:7], s[36:37] offset:0 sc1
    global_store_dwordx4 v36, v[4:7], s[36:37] offset:1024 sc1
    global_store_dwordx4 v36, v[4:7], s[36:37] offset:2048 sc1
    global_store_dwordx4 v36, v[4:7], s[36:37] offset:3072 sc1
    v_add_u32 v36, 4096, v36
    global_store_dwordx4 v36, v[4:7], s[36:37] offset:0 sc1
    s_add_u32 s40, s28, 1572864
    s_addc_u32 s41, s29, 0
    s_mul_i32 s42, s30, 163840
    s_add_u32 s36, s40, s42
    s_addc_u32 s37, s41, 0
    s_mul_i32 s42, s31, 5120
    v_add_u32 v36, s42, v2
    global_store_dwordx4 v36, v[4:7], s[36:37] offset:0 sc1
    global_store_dwordx4 v36, v[4:7], s[36:37] offset:1024 sc1
    global_store_dwordx4 v36, v[4:7], s[36:37] offset:2048 sc1
    global_store_dwordx4 v36, v[4:7], s[36:37] offset:3072 sc1
    v_add_u32 v36, 4096, v36
    global_store_dwordx4 v36, v[4:7], s[36:37] offset:0 sc1
    s_lshl_b32 s42, s30, 11
    s_lshl_b32 s43, s31, 6
    s_add_u32 s42, s42, s43
    s_add_u32 s42, s42, 0x170000
    v_add_u32 v13, s42, v2
    v_add_u32 v14, 0x150000, v13
    s_lshl_b32 s42, s2, 6
    s_add_u32 s42, s42, 0x174000
    v_add_u32 v15, s42, v2
    v_cmp_gt_u32 vcc, 4, v1
    s_and_saveexec_b64 s[50:51], vcc
    global_store_dwordx4 v13, v[4:7], s[28:29] sc1
    global_store_dwordx4 v14, v[4:7], s[28:29] sc1
    global_store_dwordx4 v15, v[4:7], s[28:29] sc1
    s_mov_b64 exec, s[50:51]
    v_mov_b32 v12, s66
    v_mov_b32 v13, s67
    s_lshl_b32 s42, s30, 14
    s_add_u32 s42, s42, 65536
    v_add_u32 v40, s42, v2
    v_add_u32 v41, 4096, v40
    v_add_u32 v42, 8192, v40
    v_add_u32 v43, 12288, v40
    s_getreg_b32 s44, hwreg(HW_REG_XCC_ID)
    s_and_b32 s44, s44, 0xffff
    v_mov_b32 v14, s44
    v_mov_b32 v15, 0
    s_lshl_b32 s42, s33, 6
    v_mov_b32 v16, s42
    s_lshl_b32 s43, s30, 11
    v_and_b32 v17, 31, v1
    v_lshlrev_b32 v17, 6, v17
    v_add_u32 v17, s43, v17
    s_mov_b32 s35, 0x8000
    s_mov_b32 s45, 0
L_h_qt:
    global_load_dwordx4 v[64:67], v40, s[28:29] offset:0 sc1
    global_load_dwordx4 v[68:71], v40, s[28:29] offset:1024 sc1
    global_load_dwordx4 v[72:75], v40, s[28:29] offset:2048 sc1
    global_load_dwordx4 v[76:79], v40, s[28:29] offset:3072 sc1
    global_load_dwordx4 v[80:83], v41, s[28:29] offset:0 sc1
    global_load_dwordx4 v[84:87], v41, s[28:29] offset:1024 sc1
    global_load_dwordx4 v[88:91], v41, s[28:29] offset:2048 sc1
    global_load_dwordx4 v[92:95], v41, s[28:29] offset:3072 sc1
    global_load_dwordx4 v[96:99], v42, s[28:29] offset:0 sc1
    global_load_dwordx4 v[100:103], v42, s[28:29] offset:1024 sc1
    global_load_dwordx4 v[104:107], v42, s[28:29] offset:2048 sc1
    global_load_dwordx4 v[108:111], v42, s[28:29] offset:3072 sc1
    global_load_dwordx4 v[112:115], v43, s[28:29] offset:0 sc1
    global_load_dwordx4 v[116:119], v43, s[28:29] offset:1024 sc1
    global_load_dwordx4 v[120:123], v43, s[28:29] offset:2048 sc1
    global_load_dwordx4 v[124:127], v43, s[28:29] offset:3072 sc1
    s_waitcnt vmcnt(0)
    s_cmp_eq_u32 s45, 0
    s_cbranch_scc0 L_h_qt_nf
    s_mov_b32 s45, 1
    v_cmp_eq_u32 vcc, 0, v1
    s_and_saveexec_b64 s[50:51], vcc
    global_store_dwordx4 v16, v[12:15], s[28:29] sc1
    s_mov_b64 exec, s[50:51]
L_h_qt_nf:
    v_mov_b32 v44, 0
    v_xor_b32 v45, v12, v66
    v_xor_b32 v46, v13, v67
    v_or3_b32 v44, v44, v45, v46
    v_xor_b32 v45, v12, v70
    v_xor_b32 v46, v13, v71
    v_or3_b32 v44, v44, v45, v46
    v_xor_b32 v45, v12, v74
    v_xor_b32 v46, v13, v75
    v_or3_b32 v44, v44, v45, v46
    v_xor_b32 v45, v12, v78
    v_xor_b32 v46, v13, v79
    v_or3_b32 v44, v44, v45, v46
    v_xor_b32 v45, v12, v82
    v_xor_b32 v46, v13, v83
    v_or3_b32 v44, v44, v45, v46
    v_xor_b32 v45, v12, v86
    v_xor_b32 v46, v13, v87
    v_or3_b32 v44, v44, v45, v46
    v_xor_b32 v45, v12, v90
    v_xor_b32 v46, v13, v91
    v_or3_b32 v44, v44, v45, v46
    v_xor_b32 v45, v12, v94
    v_xor_b32 v46, v13, v95
    v_or3_b32 v44, v44, v45, v46
    v_xor_b32 v45, v12, v98
    v_xor_b32 v46, v13, v99
    v_or3_b32 v44, v44, v45, v46
    v_xor_b32 v45, v12, v102
    v_xor_b32 v46, v13, v103
    v_or3_b32 v44, v44, v45, v46
    v_xor_b32 v45, v12, v106
    v_xor_b32 v46, v13, v107
    v_or3_b32 v44, v44, v45, v46
    v_xor_b32 v45, v12, v110
    v_xor_b32 v46, v13, v111
    v_or3_b32 v44, v44, v45, v46
    v_xor_b32 v45, v12, v114
    v_xor_b32 v46, v13, v115
    v_or3_b32 v44, v44, v45, v46
    v_xor_b32 v45, v12, v118
    v_xor_b32 v46, v13, v119
    v_or3_b32 v44, v44, v45, v46
    v_xor_b32 v45, v12, v122
    v_xor_b32 v46, v13, v123
    v_or3_b32 v44, v44, v45, v46
    v_xor_b32 v45, v12, v126
    v_xor_b32 v46, v13, v127
    v_or3_b32 v44, v44, v45, v46
    v_cmp_ne_u32 vcc, 0, v44
    s_cbranch_vccz L_h_qtd
    s_sub_u32 s35, s35, 1
    s_cbranch_scc0 L_h_qt
L_h_qtd:
    v_add_f32 v64, v64, v80
    v_add_f32 v65, v65, v81
    v_add_f32 v64, v64, v96
    v_add_f32 v65, v65, v97
    v_add_f32 v64, v64, v112
    v_add_f32 v65, v65, v113
    v_cvt_pk_bf16_f32 v44, v64, v65
    ds_write_b32 v8, v44 offset:32768
    v_add_f32 v68, v68, v84
    v_add_f32 v69, v69, v85
    v_add_f32 v68, v68, v100
    v_add_f32 v69, v69, v101
    v_add_f32 v68, v68, v116
    v_add_f32 v69, v69, v117
    v_cvt_pk_bf16_f32 v45, v68, v69
    ds_write_b32 v8, v45 offset:33040
    v_add_f32 v72, v72, v88
    v_add_f32 v73, v73, v89
    v_add_f32 v72, v72, v104
    v_add_f32 v73, v73, v105
    v_add_f32 v72, v72, v120
    v_add_f32 v73, v73, v121
    v_cvt_pk_bf16_f32 v46, v72, v73
    ds_write_b32 v8, v46 offset:33312
    v_add_f32 v76, v76, v92
    v_add_f32 v77, v77, v93
    v_add_f32 v76, v76, v108
    v_add_f32 v77, v77, v109
    v_add_f32 v76, v76, v124
    v_add_f32 v77, v77, v125
    v_cvt_pk_bf16_f32 v47, v76, v77
    ds_write_b32 v8, v47 offset:33584
    s_waitcnt vmcnt(0) lgkmcnt(0)
    v_add_u32 v19, 0, v17
    s_barrier
    s_mov_b32 s35, 0x8000
L_h_f1:
    global_load_dwordx4 v[20:23], v19, s[28:29] sc1
    s_waitcnt vmcnt(0)
    v_cmp_ne_u32 vcc, v20, v12
    v_cmp_ne_u32 s[64:65], v21, v13
    s_or_b64 vcc, vcc, s[64:65]
    s_cbranch_vccz L_h_f1_d
    s_sub_u32 s35, s35, 1
    s_cbranch_scc0 L_h_f1
L_h_f1_d:
    v_cmp_ne_u32 vcc, v22, v14
    s_mov_b32 s34, 1
    s_cbranch_vccnz L_h_mode
    s_mov_b32 s34, 0
    v_lshlrev_b32 v37, 6, v1
    s_add_u32 s40, s28, 196608
    s_addc_u32 s41, s29, 0
    s_mul_i32 s42, s30, 163840
    s_add_u32 s36, s40, s42
    s_addc_u32 s37, s41, 0
    s_mul_i32 s42, s31, 5120
    v_add_u32 v36, s42, v37
    global_load_dword v38, v36, s[36:37]
    v_add_u32 v36, 4096, v36
    v_cmp_gt_u32 vcc, 16, v1
    s_and_saveexec_b64 s[50:51], vcc
    global_load_dword v39, v36, s[36:37]
    s_mov_b64 exec, s[50:51]
    s_add_u32 s40, s28, 1572864
    s_addc_u32 s41, s29, 0
    s_mul_i32 s42, s30, 163840
    s_add_u32 s36, s40, s42
    s_addc_u32 s37, s41, 0
    s_mul_i32 s42, s31, 5120
    v_add_u32 v36, s42, v37
    global_load_dword v40, v36, s[36:37]
    v_add_u32 v36, 4096, v36
    v_cmp_gt_u32 vcc, 16, v1
    s_and_saveexec_b64 s[50:51], vcc
    global_load_dword v41, v36, s[36:37]
    s_mov_b64 exec, s[50:51]
L_h_mode:
    v_mov_b32 v24, 33888
    v_mov_b32 v25, s34
    ds_write_b32 v24, v25
    s_waitcnt lgkmcnt(0)
    s_barrier
    s_cmp_eq_u32 s31, 0
    s_cbranch_scc0 L_h_end
    s_lshl_b32 s42, s30, 2
    v_mov_b32 v24, s42
    v_mov_b32 v25, 1
    v_cmp_eq_u32 vcc, 0, v1
    s_and_saveexec_b64 s[50:51], vcc
    global_store_dword v24, v25, s[26:27] offset:192 sc1
L_h_end:
    s_mov_b64 exec, -1
    s_waitcnt vmcnt(0)
L_end:
    s_endpgm
.section .rodata,"a"
.p2align 6
.amdhsa_kernel interleave_layers__sliding_block_cached__mixer_token_mlp__decode_kernel
  .amdhsa_next_free_vgpr 256
  .amdhsa_next_free_sgpr 88
  .amdhsa_accum_offset 256
  .amdhsa_group_segment_fixed_size 0
  .amdhsa_kernarg_size 104
  .amdhsa_user_sgpr_count 2
  .amdhsa_user_sgpr_kernarg_segment_ptr 1
  .amdhsa_system_sgpr_workgroup_id_x 1
.end_amdhsa_kernel
```
